```python
import torch

def _softmax(x, axis=-1):
    return torch.softmax(x, dim=axis)

def _gelu(x):
    return torch.nn.functional.gelu(x, approximate='tanh')

def _silu(x):
    return torch.nn.functional.silu(x)

def _sigmoid(x):
    return torch.sigmoid(x)

def _layernorm(x, axis=-1, eps=1e-05):
    m = x.mean(dim=axis, keepdim=True)
    v = x.var(dim=axis, keepdim=True, unbiased=False)
    return (x - m) / torch.sqrt(v + eps)

def _scatter_add(tgt, idx, src, axis=0):
    return tgt.clone().index_add_(axis, idx, src)

def _segment_sum(src, seg, n):
    out = torch.zeros((n,) + src.shape[1:], dtype=src.dtype)
    return out.index_add_(0, seg, src)

def _pad(x, pw):
    flat = tuple((v for pair in reversed(pw) for v in pair))
    return torch.nn.functional.pad(x, flat)
kernel_name = 'adaLN_cond__sliding_block__dense_activation_squared_relu__prompt'

def setup_inputs():

    _w = lambda a: (lambda t: t.to(torch.bfloat16) if t.is_floating_point() else t)(torch.as_tensor(a))

    def _A_setup():
        B, S, D = (1, 2048, 512)
        return {'x': _w((lambda *s: torch.randn(*s, dtype=torch.bfloat16) * 0.05)(B, S, D)), 'wqkv': _w((lambda *s: torch.randn(*s, dtype=torch.bfloat16) * 0.05)(D, 3 * D)), 'wo': _w((lambda *s: torch.randn(*s, dtype=torch.bfloat16) * 0.05)(D, D))}
    _A_in = _A_setup()

    def _B_setup():
        B, S, D, F = (1, 2048, 512, 1792)
        return {'x': _w((lambda *s: torch.randn(*s, dtype=torch.bfloat16) * 0.05)(B, S, D)), 'w1': _w((lambda *s: torch.randn(*s, dtype=torch.bfloat16) * 0.05)(D, F)), 'b1': _w((lambda *s: torch.randn(*s, dtype=torch.bfloat16) * 0.4)(F)), 'w2': _w((lambda *s: torch.randn(*s, dtype=torch.bfloat16) * 0.05)(F, D)), 'b2': _w((lambda *s: torch.randn(*s, dtype=torch.bfloat16) * 3.2)(D))}
    _B_in = _B_setup()
    return {'A_x': _A_in['x'], 'A_wqkv': _A_in['wqkv'], 'A_wo': _A_in['wo'], 'B_x': _B_in['x'], 'B_w1': _B_in['w1'], 'B_b1': _B_in['b1'], 'B_w2': _B_in['w2'], 'B_b2': _B_in['b2'], 'c': _w((lambda *s: torch.randn(*s, dtype=torch.bfloat16) * 0.1)(1, 512) * 8.0), 'w_mod': _w((lambda *s: torch.randn(*s, dtype=torch.bfloat16) * 0.1)(512, 6 * 512) * 512 ** (-0.5) * 8.0)}

def reference(A_x, A_wqkv, A_wo, B_x, B_w1, B_b1, B_w2, B_b2, c, w_mod):

    def _A_ref(x, wqkv, wo):
        B, S, D = x.shape
        H = 32
        Dh = D // H
        W = 256
        qkv = (lambda x, *d: x.permute(*d))((x @ wqkv).reshape(B, S, 3, H, Dh), 2, 0, 3, 1, 4)
        q, k, v = (qkv[0], qkv[1], qkv[2])
        scores = torch.einsum('bhqd,bhkd->bhqk', q, k) * Dh ** (-0.5)
        idx = torch.arange(S)
        mask = (idx[:, None] - idx[None, :] >= 0) & (idx[:, None] - idx[None, :] < W)
        scores = torch.where(mask[None, None], scores, -1000000000.0)
        p = _softmax(scores, axis=-1)
        o = torch.einsum('bhqk,bhkd->bhqd', p, v)
        return (lambda x, *d: x.permute(*d))(o, 0, 2, 1, 3).reshape(B, S, D) @ wo

    def _B_ref(x, w1, b1, w2, b2):
        h = torch.einsum('bsd,df->bsf', x, w1) + b1
        zero = torch.zeros_like(h)
        r = torch.where(h > zero, h, zero)
        h = r * r
        out = torch.einsum('bsf,fd->bsd', h, w2) + b2
        return out
    x = A_x
    mod = (_silu(c) @ w_mod).reshape(c.shape[0], 6, 1, -1)
    sa, ca, ga, sb, cb, gb = (mod[:, 0].clone(), mod[:, 1].clone(), mod[:, 2].clone(), mod[:, 3].clone(), mod[:, 4].clone(), mod[:, 5].clone())
    h = _layernorm(x, axis=-1) * (1 + ca) + sa
    x = x + ga * _A_ref(h, A_wqkv, A_wo)
    h = _layernorm(x, axis=-1) * (1 + cb) + sb
    x = x + gb * _B_ref(h, B_w1, B_b1, B_w2, B_b2)
    return x
```

```asm
; @launch grid=(256,1,1) block=(512,1,1) lds=163840
.amdgcn_target "amdgcn-amd-amdhsa--gfx950"
.text
.globl adaLN_cond__sliding_block__dense_activation_squared_relu__prompt_kernel
.p2align 8
.type adaLN_cond__sliding_block__dense_activation_squared_relu__prompt_kernel,@function
adaLN_cond__sliding_block__dense_activation_squared_relu__prompt_kernel:
    s_cmp_ge_u32 s2, 256
    s_cbranch_scc1 END
    s_load_dwordx2 s[4:5], s[0:1], 0
    s_load_dwordx2 s[8:9], s[0:1], 8
    s_load_dwordx2 s[12:13], s[0:1], 16
    s_load_dwordx2 s[16:17], s[0:1], 32
    s_load_dwordx2 s[20:21], s[0:1], 40
    s_load_dwordx2 s[24:25], s[0:1], 48
    s_load_dwordx2 s[28:29], s[0:1], 56
    s_load_dwordx2 s[32:33], s[0:1], 64
    s_load_dwordx2 s[36:37], s[0:1], 72
    s_load_dwordx2 s[40:41], s[0:1], 80
    s_load_dwordx2 s[44:45], s[0:1], 88
    s_load_dwordx2 s[48:49], s[0:1], 96
    v_lshrrev_b32 v7, 6, v0
    v_and_b32 v1, 63, v0
    v_readfirstlane_b32 s52, v7
    s_mov_b32 s6, 0x200000
    s_mov_b32 s7, 0x00020000
    s_mov_b32 s10, 0x180000
    s_mov_b32 s11, 0x00020000
    s_mov_b32 s14, 0x80000
    s_mov_b32 s15, 0x00020000
    s_mov_b32 s18, 0x1c0000
    s_mov_b32 s19, 0x00020000
    s_mov_b32 s22, 0xe00
    s_mov_b32 s23, 0x00020000
    s_mov_b32 s26, 0x1c0000
    s_mov_b32 s27, 0x00020000
    s_mov_b32 s30, 0x400
    s_mov_b32 s31, 0x00020000
    s_mov_b32 s34, 0x400
    s_mov_b32 s35, 0x00020000
    s_mov_b32 s38, 0x300000
    s_mov_b32 s39, 0x00020000
    s_mov_b32 s42, 0x200000
    s_mov_b32 s43, 0x00020000
    s_mov_b32 s46, 0x100
    s_mov_b32 s47, 0x00020000
    s_mov_b32 s50, 0x1000000
    s_mov_b32 s51, 0x00020000
    s_and_b32 s60, s2, 7
    s_lshr_b32 s61, s2, 3
    s_lshr_b32 s62, s61, 4
    s_lshl_b32 s53, s60, 1
    s_add_u32 s53, s53, s62
    s_and_b32 s54, s61, 15
    s_and_b32 s56, s52, 3
    s_lshr_b32 s57, s52, 2
    s_and_b32 s58, s52, 1
    s_lshr_b32 s59, s52, 1
    s_mov_b32 s96, 40000
    v_lshlrev_b32 v2, 4, v1
    v_lshrrev_b32 v4, 5, v1
    v_mov_b32 v5, 0
    v_bfe_u32 v7, v1, 2, 2
    v_bfe_u32 v8, v1, 4, 1
    v_and_b32 v9, 3, v1
    v_lshlrev_b32 v3, 6, v7
    v_lshl_add_u32 v3, v8, 5, v3
    v_lshl_add_u32 v3, v9, 3, v3
    v_lshrrev_b32 v10, 2, v1
    v_lshlrev_b32 v9, 4, v9
    s_movk_i32 s60, 6144
    v_mad_u32_u24 v11, v10, s60, v9
    s_movk_i32 s60, 3072
    v_mad_u32_u24 v12, v10, s60, v9
    v_bfe_u32 v13, v1, 2, 3
    v_lshlrev_b32 v13, 12, v13
    v_lshl_add_u32 v13, v4, 6, v13
    v_add_u32 v13, v13, v9
    s_lshl_b32 s60, s53, 17
    s_lshl_b32 s61, s56, 15
    s_add_u32 s60, s60, s61
    s_lshl_b32 s61, s57, 9
    s_add_u32 s60, s60, s61
    v_and_b32 v15, 31, v1
    v_lshlrev_b32 v15, 2, v15
    s_waitcnt lgkmcnt(0)
    s_load_dword s55, s[48:49], 0
    s_cmp_ge_u32 s2, 96
    s_cbranch_scc1 NOPROD1
    s_lshl_b32 s62, s52, 7
    buffer_load_dword v176, v15, s[32:35], s62 offen
    s_mul_i32 s62, s52, 393216
    s_lshl_b32 s63, s2, 6
    s_add_u32 s62, s62, s63
    s_lshl_b32 s63, s52, 12
    s_add_u32 m0, s63, 98304
    s_nop 0
    buffer_load_dwordx4 v11, s[36:39], s62 offen lds
    s_add_u32 m0, m0, 1024
    s_add_u32 s62, s62, 98304
    buffer_load_dwordx4 v11, s[36:39], s62 offen lds
    s_add_u32 m0, m0, 1024
    s_add_u32 s62, s62, 98304
    buffer_load_dwordx4 v11, s[36:39], s62 offen lds
    s_add_u32 m0, m0, 1024
    s_add_u32 s62, s62, 98304
    buffer_load_dwordx4 v11, s[36:39], s62 offen lds
NOPROD1:
    buffer_load_dwordx4 v[24:27], v13, s[4:7], s60 offen offset:0
    buffer_load_dwordx4 v[28:31], v13, s[4:7], s60 offen offset:1024
    buffer_load_dwordx4 v[32:35], v13, s[4:7], s60 offen offset:2048
    buffer_load_dwordx4 v[36:39], v13, s[4:7], s60 offen offset:3072
    buffer_load_dwordx4 v[40:43], v13, s[4:7], s60 offen offset:128
    buffer_load_dwordx4 v[44:47], v13, s[4:7], s60 offen offset:1152
    buffer_load_dwordx4 v[48:51], v13, s[4:7], s60 offen offset:2176
    buffer_load_dwordx4 v[52:55], v13, s[4:7], s60 offen offset:3200
    buffer_load_dwordx4 v[56:59], v13, s[4:7], s60 offen offset:256
    buffer_load_dwordx4 v[60:63], v13, s[4:7], s60 offen offset:1280
    buffer_load_dwordx4 v[64:67], v13, s[4:7], s60 offen offset:2304
    buffer_load_dwordx4 v[68:71], v13, s[4:7], s60 offen offset:3328
    buffer_load_dwordx4 v[72:75], v13, s[4:7], s60 offen offset:384
    buffer_load_dwordx4 v[76:79], v13, s[4:7], s60 offen offset:1408
    buffer_load_dwordx4 v[80:83], v13, s[4:7], s60 offen offset:2432
    buffer_load_dwordx4 v[84:87], v13, s[4:7], s60 offen offset:3456
    v_lshlrev_b32 v14, 18, v1
    s_cmp_lg_u32 s52, 7
    s_cbranch_scc1 NOTLB
    buffer_load_dword v190, v14, s[48:51], 0 offen
    buffer_load_dword v190, v14, s[40:43], 0 offen
    buffer_load_dword v190, v14, s[16:19], 0 offen
    buffer_load_dword v190, v14, s[24:27], 0 offen
    buffer_load_dword v190, v14, s[12:15], 0 offen
NOTLB:
    s_barrier
    s_waitcnt lgkmcnt(0)
    s_mul_i32 s55, s55, 0x9E3779B1
    s_add_u32 s55, s55, 0x7F4A7C15
    s_getreg_b32 s3, hwreg(HW_REG_XCC_ID)
    s_cmp_lg_u32 s52, 5
    s_cbranch_scc1 NOXC
    s_lshl_b32 s62, s53, 7
    s_lshl_b32 s63, s54, 3
    s_add_u32 s62, s62, s63
    s_add_u32 s62, s62, 32768
    v_mov_b32 v188, s3
    v_mov_b32 v189, s55
    s_mov_b64 exec, 1
    buffer_store_dwordx2 v[188:189], off, s[48:51], s62 sc1
    s_mov_b64 exec, -1
NOXC:
    s_cmp_ge_u32 s2, 96
    s_cbranch_scc1 NOPROD2
    s_waitcnt vmcnt(20)
    v_lshlrev_b32 v177, 16, v176
    v_and_b32 v178, 0xffff0000, v176
    v_mul_f32 v179, 0xbfb8aa3b, v177
    v_mul_f32 v180, 0xbfb8aa3b, v178
    v_exp_f32 v179, v179
    v_exp_f32 v180, v180
    v_add_f32 v179, 1.0, v179
    v_add_f32 v180, 1.0, v180
    v_rcp_f32 v179, v179
    v_rcp_f32 v180, v180
    v_mul_f32 v177, v177, v179
    v_mul_f32 v178, v178, v180
    v_cvt_pk_bf16_f32 v176, v177, v178
    s_lshl_b32 s62, s52, 7
    s_add_u32 s63, s62, 131072
    v_add_u32 v177, s63, v15
    ds_write_b32 v177, v176
    v_lshl_add_u32 v178, v4, 4, s63
    s_waitcnt lgkmcnt(0)
    ds_read_b128 v[136:139], v178 offset:0
    ds_read_b128 v[140:143], v178 offset:32
    ds_read_b128 v[144:147], v178 offset:64
    ds_read_b128 v[148:151], v178 offset:96
    s_lshl_b32 s63, s52, 12
    s_add_u32 s63, s63, 98304
    v_lshl_add_u32 v179, v4, 9, v3
    v_add_u32 v179, s63, v179
    s_waitcnt vmcnt(16)
    ds_read_b64_tr_b16 a[0:1], v179 offset:0
    ds_read_b64_tr_b16 a[2:3], v179 offset:256
    ds_read_b64_tr_b16 a[4:5], v179 offset:1024
    ds_read_b64_tr_b16 a[6:7], v179 offset:1280
    ds_read_b64_tr_b16 a[8:9], v179 offset:2048
    ds_read_b64_tr_b16 a[10:11], v179 offset:2304
    ds_read_b64_tr_b16 a[12:13], v179 offset:3072
    ds_read_b64_tr_b16 a[14:15], v179 offset:3328
    s_waitcnt lgkmcnt(0)
    v_mfma_f32_32x32x16_bf16 v[88:103], v[136:139], a[0:3], 0
    v_mfma_f32_32x32x16_bf16 v[88:103], v[140:143], a[4:7], v[88:103]
    v_mfma_f32_32x32x16_bf16 v[88:103], v[144:147], a[8:11], v[88:103]
    v_mfma_f32_32x32x16_bf16 v[88:103], v[148:151], a[12:15], v[88:103]
    v_add_u32 v177, 1024, v177
    s_nop 7
    s_nop 2
    ds_write_b32 v177, v88
    s_waitcnt lgkmcnt(0)
    s_barrier
    s_cmp_lg_u32 s52, 0
    s_cbranch_scc1 NOPROD2
    v_and_b32 v177, 15, v1
    v_lshlrev_b32 v177, 3, v177
    v_add_u32 v178, 132096, v177
    ds_read_b64 v[136:137], v178 offset:0
    ds_read_b64 v[138:139], v178 offset:128
    ds_read_b64 v[140:141], v178 offset:256
    ds_read_b64 v[142:143], v178 offset:384
    ds_read_b64 v[144:145], v178 offset:512
    ds_read_b64 v[146:147], v178 offset:640
    ds_read_b64 v[148:149], v178 offset:768
    ds_read_b64 v[150:151], v178 offset:896
    s_waitcnt lgkmcnt(0)
    v_add_f32 v136, v136, v144
    v_add_f32 v137, v137, v145
    v_add_f32 v138, v138, v146
    v_add_f32 v139, v139, v147
    v_add_f32 v140, v140, v148
    v_add_f32 v141, v141, v149
    v_add_f32 v142, v142, v150
    v_add_f32 v143, v143, v151
    v_add_f32 v136, v136, v140
    v_add_f32 v137, v137, v141
    v_add_f32 v138, v138, v142
    v_add_f32 v139, v139, v143
    v_add_f32 v136, v136, v138
    v_add_f32 v137, v137, v139
    v_cvt_pk_bf16_f32 v136, v136, v137
    v_mov_b32 v137, s55
    s_lshl_b32 s62, s2, 7
    s_add_u32 s62, s62, 4096
    s_mov_b64 exec, 0xffff
    buffer_store_dwordx2 v[136:137], v177, s[48:51], s62 offen sc1
    s_mov_b64 exec, -1
NOPROD2:
    s_mul_i32 s62, s52, 196608
    s_lshl_b32 s63, s54, 6
    s_add_u32 s62, s62, s63
    s_mul_i32 m0, s52, 12288
    s_nop 0
    buffer_load_dwordx4 v12, s[8:11], s62 offen offset:1024 lds
    buffer_load_dwordx4 v12, s[8:11], s62 offen offset:2048 lds
    buffer_load_dwordx4 v12, s[8:11], s62 offen lds
    s_add_u32 m0, m0, 3072
    s_add_u32 s62, s62, 49152
    buffer_load_dwordx4 v12, s[8:11], s62 offen offset:1024 lds
    buffer_load_dwordx4 v12, s[8:11], s62 offen offset:2048 lds
    buffer_load_dwordx4 v12, s[8:11], s62 offen lds
    s_mov_b32 s98, 0x3f803f80
    v_mov_b32 v176, 0
    v_mov_b32 v177, 0
    v_mov_b32 v178, 0
    v_mov_b32 v179, 0
    v_mov_b32 v180, 0
    v_mov_b32 v181, 0
    v_mov_b32 v182, 0
    v_mov_b32 v183, 0
    s_waitcnt vmcnt(18)
    s_mov_b32 vcc_lo, 0x55555555
    s_mov_b32 vcc_hi, 0x55555555
    v_cndmask_b32_dpp v136, v28, v24, vcc quad_perm:[1,0,3,2] row_mask:0xf bank_mask:0xf
    v_cndmask_b32_dpp v137, v29, v25, vcc quad_perm:[1,0,3,2] row_mask:0xf bank_mask:0xf
    v_cndmask_b32_dpp v138, v30, v26, vcc quad_perm:[1,0,3,2] row_mask:0xf bank_mask:0xf
    v_cndmask_b32_dpp v139, v31, v27, vcc quad_perm:[1,0,3,2] row_mask:0xf bank_mask:0xf
    v_cndmask_b32_dpp v144, v36, v32, vcc quad_perm:[1,0,3,2] row_mask:0xf bank_mask:0xf
    v_cndmask_b32_dpp v145, v37, v33, vcc quad_perm:[1,0,3,2] row_mask:0xf bank_mask:0xf
    v_cndmask_b32_dpp v146, v38, v34, vcc quad_perm:[1,0,3,2] row_mask:0xf bank_mask:0xf
    v_cndmask_b32_dpp v147, v39, v35, vcc quad_perm:[1,0,3,2] row_mask:0xf bank_mask:0xf
    s_mov_b32 vcc_lo, 0xaaaaaaaa
    s_mov_b32 vcc_hi, 0xaaaaaaaa
    v_cndmask_b32_dpp v140, v24, v28, vcc quad_perm:[1,0,3,2] row_mask:0xf bank_mask:0xf
    v_cndmask_b32_dpp v141, v25, v29, vcc quad_perm:[1,0,3,2] row_mask:0xf bank_mask:0xf
    v_cndmask_b32_dpp v142, v26, v30, vcc quad_perm:[1,0,3,2] row_mask:0xf bank_mask:0xf
    v_cndmask_b32_dpp v143, v27, v31, vcc quad_perm:[1,0,3,2] row_mask:0xf bank_mask:0xf
    v_cndmask_b32_dpp v148, v32, v36, vcc quad_perm:[1,0,3,2] row_mask:0xf bank_mask:0xf
    v_cndmask_b32_dpp v149, v33, v37, vcc quad_perm:[1,0,3,2] row_mask:0xf bank_mask:0xf
    v_cndmask_b32_dpp v150, v34, v38, vcc quad_perm:[1,0,3,2] row_mask:0xf bank_mask:0xf
    v_cndmask_b32_dpp v151, v35, v39, vcc quad_perm:[1,0,3,2] row_mask:0xf bank_mask:0xf
    s_mov_b32 vcc_lo, 0x33333333
    s_mov_b32 vcc_hi, 0x33333333
    v_cndmask_b32_dpp v24, v144, v136, vcc quad_perm:[2,3,0,1] row_mask:0xf bank_mask:0xf
    v_cndmask_b32_dpp v25, v145, v137, vcc quad_perm:[2,3,0,1] row_mask:0xf bank_mask:0xf
    v_cndmask_b32_dpp v26, v146, v138, vcc quad_perm:[2,3,0,1] row_mask:0xf bank_mask:0xf
    v_cndmask_b32_dpp v27, v147, v139, vcc quad_perm:[2,3,0,1] row_mask:0xf bank_mask:0xf
    v_cndmask_b32_dpp v28, v148, v140, vcc quad_perm:[2,3,0,1] row_mask:0xf bank_mask:0xf
    v_cndmask_b32_dpp v29, v149, v141, vcc quad_perm:[2,3,0,1] row_mask:0xf bank_mask:0xf
    v_cndmask_b32_dpp v30, v150, v142, vcc quad_perm:[2,3,0,1] row_mask:0xf bank_mask:0xf
    v_cndmask_b32_dpp v31, v151, v143, vcc quad_perm:[2,3,0,1] row_mask:0xf bank_mask:0xf
    s_mov_b32 vcc_lo, 0xcccccccc
    s_mov_b32 vcc_hi, 0xcccccccc
    v_cndmask_b32_dpp v32, v136, v144, vcc quad_perm:[2,3,0,1] row_mask:0xf bank_mask:0xf
    v_cndmask_b32_dpp v33, v137, v145, vcc quad_perm:[2,3,0,1] row_mask:0xf bank_mask:0xf
    v_cndmask_b32_dpp v34, v138, v146, vcc quad_perm:[2,3,0,1] row_mask:0xf bank_mask:0xf
    v_cndmask_b32_dpp v35, v139, v147, vcc quad_perm:[2,3,0,1] row_mask:0xf bank_mask:0xf
    v_cndmask_b32_dpp v36, v140, v148, vcc quad_perm:[2,3,0,1] row_mask:0xf bank_mask:0xf
    v_cndmask_b32_dpp v37, v141, v149, vcc quad_perm:[2,3,0,1] row_mask:0xf bank_mask:0xf
    v_cndmask_b32_dpp v38, v142, v150, vcc quad_perm:[2,3,0,1] row_mask:0xf bank_mask:0xf
    v_cndmask_b32_dpp v39, v143, v151, vcc quad_perm:[2,3,0,1] row_mask:0xf bank_mask:0xf
    v_dot2c_f32_bf16 v176, s98, v24
    v_dot2c_f32_bf16 v180, v24, v24
    v_dot2c_f32_bf16 v177, s98, v25
    v_dot2c_f32_bf16 v181, v25, v25
    v_dot2c_f32_bf16 v178, s98, v26
    v_dot2c_f32_bf16 v182, v26, v26
    v_dot2c_f32_bf16 v179, s98, v27
    v_dot2c_f32_bf16 v183, v27, v27
    v_dot2c_f32_bf16 v176, s98, v28
    v_dot2c_f32_bf16 v180, v28, v28
    v_dot2c_f32_bf16 v177, s98, v29
    v_dot2c_f32_bf16 v181, v29, v29
    v_dot2c_f32_bf16 v178, s98, v30
    v_dot2c_f32_bf16 v182, v30, v30
    v_dot2c_f32_bf16 v179, s98, v31
    v_dot2c_f32_bf16 v183, v31, v31
    v_dot2c_f32_bf16 v176, s98, v32
    v_dot2c_f32_bf16 v180, v32, v32
    v_dot2c_f32_bf16 v177, s98, v33
    v_dot2c_f32_bf16 v181, v33, v33
    v_dot2c_f32_bf16 v178, s98, v34
    v_dot2c_f32_bf16 v182, v34, v34
    v_dot2c_f32_bf16 v179, s98, v35
    v_dot2c_f32_bf16 v183, v35, v35
    v_dot2c_f32_bf16 v176, s98, v36
    v_dot2c_f32_bf16 v180, v36, v36
    v_dot2c_f32_bf16 v177, s98, v37
    v_dot2c_f32_bf16 v181, v37, v37
    v_dot2c_f32_bf16 v178, s98, v38
    v_dot2c_f32_bf16 v182, v38, v38
    v_dot2c_f32_bf16 v179, s98, v39
    v_dot2c_f32_bf16 v183, v39, v39
    s_add_u32 m0, m0, 3072
    s_add_u32 s62, s62, 49152
    buffer_load_dwordx4 v12, s[8:11], s62 offen offset:1024 lds
    buffer_load_dwordx4 v12, s[8:11], s62 offen offset:2048 lds
    buffer_load_dwordx4 v12, s[8:11], s62 offen lds
    s_waitcnt vmcnt(17)
    s_mov_b32 vcc_lo, 0x55555555
    s_mov_b32 vcc_hi, 0x55555555
    v_cndmask_b32_dpp v136, v44, v40, vcc quad_perm:[1,0,3,2] row_mask:0xf bank_mask:0xf
    v_cndmask_b32_dpp v137, v45, v41, vcc quad_perm:[1,0,3,2] row_mask:0xf bank_mask:0xf
    v_cndmask_b32_dpp v138, v46, v42, vcc quad_perm:[1,0,3,2] row_mask:0xf bank_mask:0xf
    v_cndmask_b32_dpp v139, v47, v43, vcc quad_perm:[1,0,3,2] row_mask:0xf bank_mask:0xf
    v_cndmask_b32_dpp v144, v52, v48, vcc quad_perm:[1,0,3,2] row_mask:0xf bank_mask:0xf
    v_cndmask_b32_dpp v145, v53, v49, vcc quad_perm:[1,0,3,2] row_mask:0xf bank_mask:0xf
    v_cndmask_b32_dpp v146, v54, v50, vcc quad_perm:[1,0,3,2] row_mask:0xf bank_mask:0xf
    v_cndmask_b32_dpp v147, v55, v51, vcc quad_perm:[1,0,3,2] row_mask:0xf bank_mask:0xf
    s_mov_b32 vcc_lo, 0xaaaaaaaa
    s_mov_b32 vcc_hi, 0xaaaaaaaa
    v_cndmask_b32_dpp v140, v40, v44, vcc quad_perm:[1,0,3,2] row_mask:0xf bank_mask:0xf
    v_cndmask_b32_dpp v141, v41, v45, vcc quad_perm:[1,0,3,2] row_mask:0xf bank_mask:0xf
    v_cndmask_b32_dpp v142, v42, v46, vcc quad_perm:[1,0,3,2] row_mask:0xf bank_mask:0xf
    v_cndmask_b32_dpp v143, v43, v47, vcc quad_perm:[1,0,3,2] row_mask:0xf bank_mask:0xf
    v_cndmask_b32_dpp v148, v48, v52, vcc quad_perm:[1,0,3,2] row_mask:0xf bank_mask:0xf
    v_cndmask_b32_dpp v149, v49, v53, vcc quad_perm:[1,0,3,2] row_mask:0xf bank_mask:0xf
    v_cndmask_b32_dpp v150, v50, v54, vcc quad_perm:[1,0,3,2] row_mask:0xf bank_mask:0xf
    v_cndmask_b32_dpp v151, v51, v55, vcc quad_perm:[1,0,3,2] row_mask:0xf bank_mask:0xf
    s_mov_b32 vcc_lo, 0x33333333
    s_mov_b32 vcc_hi, 0x33333333
    v_cndmask_b32_dpp v40, v144, v136, vcc quad_perm:[2,3,0,1] row_mask:0xf bank_mask:0xf
    v_cndmask_b32_dpp v41, v145, v137, vcc quad_perm:[2,3,0,1] row_mask:0xf bank_mask:0xf
    v_cndmask_b32_dpp v42, v146, v138, vcc quad_perm:[2,3,0,1] row_mask:0xf bank_mask:0xf
    v_cndmask_b32_dpp v43, v147, v139, vcc quad_perm:[2,3,0,1] row_mask:0xf bank_mask:0xf
    v_cndmask_b32_dpp v44, v148, v140, vcc quad_perm:[2,3,0,1] row_mask:0xf bank_mask:0xf
    v_cndmask_b32_dpp v45, v149, v141, vcc quad_perm:[2,3,0,1] row_mask:0xf bank_mask:0xf
    v_cndmask_b32_dpp v46, v150, v142, vcc quad_perm:[2,3,0,1] row_mask:0xf bank_mask:0xf
    v_cndmask_b32_dpp v47, v151, v143, vcc quad_perm:[2,3,0,1] row_mask:0xf bank_mask:0xf
    s_mov_b32 vcc_lo, 0xcccccccc
    s_mov_b32 vcc_hi, 0xcccccccc
    v_cndmask_b32_dpp v48, v136, v144, vcc quad_perm:[2,3,0,1] row_mask:0xf bank_mask:0xf
    v_cndmask_b32_dpp v49, v137, v145, vcc quad_perm:[2,3,0,1] row_mask:0xf bank_mask:0xf
    v_cndmask_b32_dpp v50, v138, v146, vcc quad_perm:[2,3,0,1] row_mask:0xf bank_mask:0xf
    v_cndmask_b32_dpp v51, v139, v147, vcc quad_perm:[2,3,0,1] row_mask:0xf bank_mask:0xf
    v_cndmask_b32_dpp v52, v140, v148, vcc quad_perm:[2,3,0,1] row_mask:0xf bank_mask:0xf
    v_cndmask_b32_dpp v53, v141, v149, vcc quad_perm:[2,3,0,1] row_mask:0xf bank_mask:0xf
    v_cndmask_b32_dpp v54, v142, v150, vcc quad_perm:[2,3,0,1] row_mask:0xf bank_mask:0xf
    v_cndmask_b32_dpp v55, v143, v151, vcc quad_perm:[2,3,0,1] row_mask:0xf bank_mask:0xf
    v_dot2c_f32_bf16 v176, s98, v40
    v_dot2c_f32_bf16 v180, v40, v40
    v_dot2c_f32_bf16 v177, s98, v41
    v_dot2c_f32_bf16 v181, v41, v41
    v_dot2c_f32_bf16 v178, s98, v42
    v_dot2c_f32_bf16 v182, v42, v42
    v_dot2c_f32_bf16 v179, s98, v43
    v_dot2c_f32_bf16 v183, v43, v43
    v_dot2c_f32_bf16 v176, s98, v44
    v_dot2c_f32_bf16 v180, v44, v44
    v_dot2c_f32_bf16 v177, s98, v45
    v_dot2c_f32_bf16 v181, v45, v45
    v_dot2c_f32_bf16 v178, s98, v46
    v_dot2c_f32_bf16 v182, v46, v46
    v_dot2c_f32_bf16 v179, s98, v47
    v_dot2c_f32_bf16 v183, v47, v47
    v_dot2c_f32_bf16 v176, s98, v48
    v_dot2c_f32_bf16 v180, v48, v48
    v_dot2c_f32_bf16 v177, s98, v49
    v_dot2c_f32_bf16 v181, v49, v49
    v_dot2c_f32_bf16 v178, s98, v50
    v_dot2c_f32_bf16 v182, v50, v50
    v_dot2c_f32_bf16 v179, s98, v51
    v_dot2c_f32_bf16 v183, v51, v51
    v_dot2c_f32_bf16 v176, s98, v52
    v_dot2c_f32_bf16 v180, v52, v52
    v_dot2c_f32_bf16 v177, s98, v53
    v_dot2c_f32_bf16 v181, v53, v53
    v_dot2c_f32_bf16 v178, s98, v54
    v_dot2c_f32_bf16 v182, v54, v54
    v_dot2c_f32_bf16 v179, s98, v55
    v_dot2c_f32_bf16 v183, v55, v55
    s_add_u32 m0, m0, 3072
    s_add_u32 s62, s62, 49152
    buffer_load_dwordx4 v12, s[8:11], s62 offen offset:1024 lds
    buffer_load_dwordx4 v12, s[8:11], s62 offen offset:2048 lds
    buffer_load_dwordx4 v12, s[8:11], s62 offen lds
    s_waitcnt vmcnt(16)
    s_mov_b32 vcc_lo, 0x55555555
    s_mov_b32 vcc_hi, 0x55555555
    v_cndmask_b32_dpp v136, v60, v56, vcc quad_perm:[1,0,3,2] row_mask:0xf bank_mask:0xf
    v_cndmask_b32_dpp v137, v61, v57, vcc quad_perm:[1,0,3,2] row_mask:0xf bank_mask:0xf
    v_cndmask_b32_dpp v138, v62, v58, vcc quad_perm:[1,0,3,2] row_mask:0xf bank_mask:0xf
    v_cndmask_b32_dpp v139, v63, v59, vcc quad_perm:[1,0,3,2] row_mask:0xf bank_mask:0xf
    v_cndmask_b32_dpp v144, v68, v64, vcc quad_perm:[1,0,3,2] row_mask:0xf bank_mask:0xf
    v_cndmask_b32_dpp v145, v69, v65, vcc quad_perm:[1,0,3,2] row_mask:0xf bank_mask:0xf
    v_cndmask_b32_dpp v146, v70, v66, vcc quad_perm:[1,0,3,2] row_mask:0xf bank_mask:0xf
    v_cndmask_b32_dpp v147, v71, v67, vcc quad_perm:[1,0,3,2] row_mask:0xf bank_mask:0xf
    s_mov_b32 vcc_lo, 0xaaaaaaaa
    s_mov_b32 vcc_hi, 0xaaaaaaaa
    v_cndmask_b32_dpp v140, v56, v60, vcc quad_perm:[1,0,3,2] row_mask:0xf bank_mask:0xf
    v_cndmask_b32_dpp v141, v57, v61, vcc quad_perm:[1,0,3,2] row_mask:0xf bank_mask:0xf
    v_cndmask_b32_dpp v142, v58, v62, vcc quad_perm:[1,0,3,2] row_mask:0xf bank_mask:0xf
    v_cndmask_b32_dpp v143, v59, v63, vcc quad_perm:[1,0,3,2] row_mask:0xf bank_mask:0xf
    v_cndmask_b32_dpp v148, v64, v68, vcc quad_perm:[1,0,3,2] row_mask:0xf bank_mask:0xf
    v_cndmask_b32_dpp v149, v65, v69, vcc quad_perm:[1,0,3,2] row_mask:0xf bank_mask:0xf
    v_cndmask_b32_dpp v150, v66, v70, vcc quad_perm:[1,0,3,2] row_mask:0xf bank_mask:0xf
    v_cndmask_b32_dpp v151, v67, v71, vcc quad_perm:[1,0,3,2] row_mask:0xf bank_mask:0xf
    s_mov_b32 vcc_lo, 0x33333333
    s_mov_b32 vcc_hi, 0x33333333
    v_cndmask_b32_dpp v56, v144, v136, vcc quad_perm:[2,3,0,1] row_mask:0xf bank_mask:0xf
    v_cndmask_b32_dpp v57, v145, v137, vcc quad_perm:[2,3,0,1] row_mask:0xf bank_mask:0xf
    v_cndmask_b32_dpp v58, v146, v138, vcc quad_perm:[2,3,0,1] row_mask:0xf bank_mask:0xf
    v_cndmask_b32_dpp v59, v147, v139, vcc quad_perm:[2,3,0,1] row_mask:0xf bank_mask:0xf
    v_cndmask_b32_dpp v60, v148, v140, vcc quad_perm:[2,3,0,1] row_mask:0xf bank_mask:0xf
    v_cndmask_b32_dpp v61, v149, v141, vcc quad_perm:[2,3,0,1] row_mask:0xf bank_mask:0xf
    v_cndmask_b32_dpp v62, v150, v142, vcc quad_perm:[2,3,0,1] row_mask:0xf bank_mask:0xf
    v_cndmask_b32_dpp v63, v151, v143, vcc quad_perm:[2,3,0,1] row_mask:0xf bank_mask:0xf
    s_mov_b32 vcc_lo, 0xcccccccc
    s_mov_b32 vcc_hi, 0xcccccccc
    v_cndmask_b32_dpp v64, v136, v144, vcc quad_perm:[2,3,0,1] row_mask:0xf bank_mask:0xf
    v_cndmask_b32_dpp v65, v137, v145, vcc quad_perm:[2,3,0,1] row_mask:0xf bank_mask:0xf
    v_cndmask_b32_dpp v66, v138, v146, vcc quad_perm:[2,3,0,1] row_mask:0xf bank_mask:0xf
    v_cndmask_b32_dpp v67, v139, v147, vcc quad_perm:[2,3,0,1] row_mask:0xf bank_mask:0xf
    v_cndmask_b32_dpp v68, v140, v148, vcc quad_perm:[2,3,0,1] row_mask:0xf bank_mask:0xf
    v_cndmask_b32_dpp v69, v141, v149, vcc quad_perm:[2,3,0,1] row_mask:0xf bank_mask:0xf
    v_cndmask_b32_dpp v70, v142, v150, vcc quad_perm:[2,3,0,1] row_mask:0xf bank_mask:0xf
    v_cndmask_b32_dpp v71, v143, v151, vcc quad_perm:[2,3,0,1] row_mask:0xf bank_mask:0xf
    v_dot2c_f32_bf16 v176, s98, v56
    v_dot2c_f32_bf16 v180, v56, v56
    v_dot2c_f32_bf16 v177, s98, v57
    v_dot2c_f32_bf16 v181, v57, v57
    v_dot2c_f32_bf16 v178, s98, v58
    v_dot2c_f32_bf16 v182, v58, v58
    v_dot2c_f32_bf16 v179, s98, v59
    v_dot2c_f32_bf16 v183, v59, v59
    v_dot2c_f32_bf16 v176, s98, v60
    v_dot2c_f32_bf16 v180, v60, v60
    v_dot2c_f32_bf16 v177, s98, v61
    v_dot2c_f32_bf16 v181, v61, v61
    v_dot2c_f32_bf16 v178, s98, v62
    v_dot2c_f32_bf16 v182, v62, v62
    v_dot2c_f32_bf16 v179, s98, v63
    v_dot2c_f32_bf16 v183, v63, v63
    v_dot2c_f32_bf16 v176, s98, v64
    v_dot2c_f32_bf16 v180, v64, v64
    v_dot2c_f32_bf16 v177, s98, v65
    v_dot2c_f32_bf16 v181, v65, v65
    v_dot2c_f32_bf16 v178, s98, v66
    v_dot2c_f32_bf16 v182, v66, v66
    v_dot2c_f32_bf16 v179, s98, v67
    v_dot2c_f32_bf16 v183, v67, v67
    v_dot2c_f32_bf16 v176, s98, v68
    v_dot2c_f32_bf16 v180, v68, v68
    v_dot2c_f32_bf16 v177, s98, v69
    v_dot2c_f32_bf16 v181, v69, v69
    v_dot2c_f32_bf16 v178, s98, v70
    v_dot2c_f32_bf16 v182, v70, v70
    v_dot2c_f32_bf16 v179, s98, v71
    v_dot2c_f32_bf16 v183, v71, v71
    s_waitcnt vmcnt(12)
    s_mov_b32 vcc_lo, 0x55555555
    s_mov_b32 vcc_hi, 0x55555555
    v_cndmask_b32_dpp v136, v76, v72, vcc quad_perm:[1,0,3,2] row_mask:0xf bank_mask:0xf
    v_cndmask_b32_dpp v137, v77, v73, vcc quad_perm:[1,0,3,2] row_mask:0xf bank_mask:0xf
    v_cndmask_b32_dpp v138, v78, v74, vcc quad_perm:[1,0,3,2] row_mask:0xf bank_mask:0xf
    v_cndmask_b32_dpp v139, v79, v75, vcc quad_perm:[1,0,3,2] row_mask:0xf bank_mask:0xf
    v_cndmask_b32_dpp v144, v84, v80, vcc quad_perm:[1,0,3,2] row_mask:0xf bank_mask:0xf
    v_cndmask_b32_dpp v145, v85, v81, vcc quad_perm:[1,0,3,2] row_mask:0xf bank_mask:0xf
    v_cndmask_b32_dpp v146, v86, v82, vcc quad_perm:[1,0,3,2] row_mask:0xf bank_mask:0xf
    v_cndmask_b32_dpp v147, v87, v83, vcc quad_perm:[1,0,3,2] row_mask:0xf bank_mask:0xf
    s_mov_b32 vcc_lo, 0xaaaaaaaa
    s_mov_b32 vcc_hi, 0xaaaaaaaa
    v_cndmask_b32_dpp v140, v72, v76, vcc quad_perm:[1,0,3,2] row_mask:0xf bank_mask:0xf
    v_cndmask_b32_dpp v141, v73, v77, vcc quad_perm:[1,0,3,2] row_mask:0xf bank_mask:0xf
    v_cndmask_b32_dpp v142, v74, v78, vcc quad_perm:[1,0,3,2] row_mask:0xf bank_mask:0xf
    v_cndmask_b32_dpp v143, v75, v79, vcc quad_perm:[1,0,3,2] row_mask:0xf bank_mask:0xf
    v_cndmask_b32_dpp v148, v80, v84, vcc quad_perm:[1,0,3,2] row_mask:0xf bank_mask:0xf
    v_cndmask_b32_dpp v149, v81, v85, vcc quad_perm:[1,0,3,2] row_mask:0xf bank_mask:0xf
    v_cndmask_b32_dpp v150, v82, v86, vcc quad_perm:[1,0,3,2] row_mask:0xf bank_mask:0xf
    v_cndmask_b32_dpp v151, v83, v87, vcc quad_perm:[1,0,3,2] row_mask:0xf bank_mask:0xf
    s_mov_b32 vcc_lo, 0x33333333
    s_mov_b32 vcc_hi, 0x33333333
    v_cndmask_b32_dpp v72, v144, v136, vcc quad_perm:[2,3,0,1] row_mask:0xf bank_mask:0xf
    v_cndmask_b32_dpp v73, v145, v137, vcc quad_perm:[2,3,0,1] row_mask:0xf bank_mask:0xf
    v_cndmask_b32_dpp v74, v146, v138, vcc quad_perm:[2,3,0,1] row_mask:0xf bank_mask:0xf
    v_cndmask_b32_dpp v75, v147, v139, vcc quad_perm:[2,3,0,1] row_mask:0xf bank_mask:0xf
    v_cndmask_b32_dpp v76, v148, v140, vcc quad_perm:[2,3,0,1] row_mask:0xf bank_mask:0xf
    v_cndmask_b32_dpp v77, v149, v141, vcc quad_perm:[2,3,0,1] row_mask:0xf bank_mask:0xf
    v_cndmask_b32_dpp v78, v150, v142, vcc quad_perm:[2,3,0,1] row_mask:0xf bank_mask:0xf
    v_cndmask_b32_dpp v79, v151, v143, vcc quad_perm:[2,3,0,1] row_mask:0xf bank_mask:0xf
    s_mov_b32 vcc_lo, 0xcccccccc
    s_mov_b32 vcc_hi, 0xcccccccc
    v_cndmask_b32_dpp v80, v136, v144, vcc quad_perm:[2,3,0,1] row_mask:0xf bank_mask:0xf
    v_cndmask_b32_dpp v81, v137, v145, vcc quad_perm:[2,3,0,1] row_mask:0xf bank_mask:0xf
    v_cndmask_b32_dpp v82, v138, v146, vcc quad_perm:[2,3,0,1] row_mask:0xf bank_mask:0xf
    v_cndmask_b32_dpp v83, v139, v147, vcc quad_perm:[2,3,0,1] row_mask:0xf bank_mask:0xf
    v_cndmask_b32_dpp v84, v140, v148, vcc quad_perm:[2,3,0,1] row_mask:0xf bank_mask:0xf
    v_cndmask_b32_dpp v85, v141, v149, vcc quad_perm:[2,3,0,1] row_mask:0xf bank_mask:0xf
    v_cndmask_b32_dpp v86, v142, v150, vcc quad_perm:[2,3,0,1] row_mask:0xf bank_mask:0xf
    v_cndmask_b32_dpp v87, v143, v151, vcc quad_perm:[2,3,0,1] row_mask:0xf bank_mask:0xf
    v_dot2c_f32_bf16 v176, s98, v72
    v_dot2c_f32_bf16 v180, v72, v72
    v_dot2c_f32_bf16 v177, s98, v73
    v_dot2c_f32_bf16 v181, v73, v73
    v_dot2c_f32_bf16 v178, s98, v74
    v_dot2c_f32_bf16 v182, v74, v74
    v_dot2c_f32_bf16 v179, s98, v75
    v_dot2c_f32_bf16 v183, v75, v75
    v_dot2c_f32_bf16 v176, s98, v76
    v_dot2c_f32_bf16 v180, v76, v76
    v_dot2c_f32_bf16 v177, s98, v77
    v_dot2c_f32_bf16 v181, v77, v77
    v_dot2c_f32_bf16 v178, s98, v78
    v_dot2c_f32_bf16 v182, v78, v78
    v_dot2c_f32_bf16 v179, s98, v79
    v_dot2c_f32_bf16 v183, v79, v79
    v_dot2c_f32_bf16 v176, s98, v80
    v_dot2c_f32_bf16 v180, v80, v80
    v_dot2c_f32_bf16 v177, s98, v81
    v_dot2c_f32_bf16 v181, v81, v81
    v_dot2c_f32_bf16 v178, s98, v82
    v_dot2c_f32_bf16 v182, v82, v82
    v_dot2c_f32_bf16 v179, s98, v83
    v_dot2c_f32_bf16 v183, v83, v83
    v_dot2c_f32_bf16 v176, s98, v84
    v_dot2c_f32_bf16 v180, v84, v84
    v_dot2c_f32_bf16 v177, s98, v85
    v_dot2c_f32_bf16 v181, v85, v85
    v_dot2c_f32_bf16 v178, s98, v86
    v_dot2c_f32_bf16 v182, v86, v86
    v_dot2c_f32_bf16 v179, s98, v87
    v_dot2c_f32_bf16 v183, v87, v87
    v_add_f32 v176, v176, v177
    s_nop 0
    v_add_f32 v178, v178, v179
    v_add_f32 v180, v180, v181
    v_add_f32 v182, v182, v183
    v_add_f32 v176, v176, v178
    v_add_f32 v180, v180, v182
    v_mov_b32 v177, v180
    v_mov_b32 v178, v176
    s_nop 1
    v_permlane32_swap_b32 v178, v176
    v_add_f32 v176, v176, v178
    v_mov_b32 v179, v177
    s_nop 1
    v_permlane32_swap_b32 v179, v177
    v_add_f32 v177, v177, v179
    v_lshlrev_b32 v178, 1, v15
    s_lshl_b32 s62, s52, 8
    s_add_u32 s63, s62, 133120
    v_add_u32 v179, s63, v178
    ds_write_b64 v179, v[176:177]
    s_xor_b32 s62, s62, 1024
    s_add_u32 s63, s62, 133120
    v_add_u32 v179, s63, v178
    s_cmp_ge_u32 s52, 4
    s_cbranch_scc1 NOG1
    v_lshlrev_b32 v136, 4, v0
    s_mov_b32 s99, 4096
MG_1:
    buffer_load_dwordx4 v[140:143], v136, s[48:51], s99 offen offset:0 sc1
    s_waitcnt vmcnt(0)
    v_cmp_ne_u32 vcc, s55, v141
    v_cmp_ne_u32 s[62:63], s55, v143
    s_nop 0
    s_or_b64 vcc, vcc, s[62:63]
    s_cbranch_vccz MGD_2
    s_cmp_eq_u32 s96, 0
    s_cbranch_scc1 MGD_2
    s_sub_u32 s96, s96, 1
    s_sleep 1
    s_branch MG_1
MGD_2:
    v_lshlrev_b32 v144, 16, v140
    v_and_b32 v145, 0xffff0000, v140
    v_lshlrev_b32 v146, 16, v142
    v_and_b32 v147, 0xffff0000, v142
    s_cmp_ge_u32 s52, 2
    s_cselect_b32 s62, 1.0, 0
    v_add_f32 v144, s62, v144
    v_add_f32 v145, s62, v145
    v_add_f32 v146, s62, v146
    v_add_f32 v147, s62, v147
    v_add_u32 v136, 147456, v136
    ds_write_b128 v136, v[144:147]
NOG1:
    s_waitcnt vmcnt(0) lgkmcnt(0)
    s_barrier
    ds_read_b64 v[180:181], v179
    s_lshl_b32 s62, s53, 7
    s_add_u32 s62, s62, 32768
    v_and_b32 v14, 15, v1
    v_lshlrev_b32 v14, 3, v14
    buffer_load_dwordx2 v[188:189], v14, s[48:51], s62 offen sc1
    s_lshl_b32 s62, s53, 2
    s_add_u32 s63, s62, s56
    s_mul_i32 s98, s63, 112
    s_lshl_b32 s99, s54, 3
    s_add_u32 s98, s98, s99
    s_lshl_b32 s99, s57, 2
    s_add_u32 s98, s98, s99
    s_lshl_b32 s98, s98, 10
    s_add_u32 s98, s98, 9437184
    s_lshl_b32 s63, s63, 5
    s_lshl_b32 s99, s54, 1
    s_add_u32 s63, s63, s99
    s_add_u32 s63, s63, s57
    s_lshl_b32 s63, s63, 10
    s_add_u32 s63, s63, 5238784
    v_mov_b32 v14, s63
    v_mov_b32 v190, s98
    v_cmp_gt_u32 vcc, 32, v1
    s_nop 1
    v_cndmask_b32 v14, v14, v190, vcc
    v_lshl_add_u32 v14, v1, 7, v14
    s_lshr_b32 s63, s54, 3
    s_lshl_b32 s63, s63, 1
    s_add_u32 s63, s63, s62
    s_add_u32 s63, s63, s58
    s_lshl_b32 s63, s63, 3
    s_and_b32 s99, s54, 7
    s_add_u32 s63, s63, s99
    s_lshl_b32 s98, s63, 12
    s_lshl_b32 s99, s59, 7
    s_add_u32 s98, s98, s99
    s_add_u32 s98, s98, 7340032
    v_and_b32 v190, 7, v1
    v_lshl_add_u32 v190, v190, 9, s98
    v_cmp_gt_u32 vcc, 40, v1
    s_nop 1
    v_cndmask_b32 v14, v190, v14, vcc
    s_lshl_b32 s63, s63, 8
    s_lshl_b32 s99, s59, 6
    s_add_u32 s63, s63, s99
    s_add_u32 s63, s63, 65536
    v_mov_b32 v190, s63
    v_cmp_gt_u32 vcc, 48, v1
    s_nop 1
    v_cndmask_b32 v14, v190, v14, vcc
    v_accvgpr_write_b32 a63, v14
    s_lshr_b32 s62, s2, 3
    s_lshl_b32 s62, s62, 3
    s_add_u32 s62, s62, s52
    s_lshl_b32 s63, s62, 14
    v_lshlrev_b32 v14, 7, v1
    s_cmp_ge_u32 s62, 32
    s_cbranch_scc1 PF1
    buffer_load_dword v191, v14, s[12:15], s63 offen
    s_add_u32 s63, s63, 8192
    buffer_load_dword v191, v14, s[12:15], s63 offen
    s_branch PF3
PF1:
    s_cmp_ge_u32 s62, 144
    s_cbranch_scc1 PF2
    s_sub_u32 s63, s63, 524288
    buffer_load_dword v191, v14, s[16:19], s63 offen
    s_add_u32 s63, s63, 8192
    buffer_load_dword v191, v14, s[16:19], s63 offen
    s_branch PF3
PF2:
    s_sub_u32 s63, s63, 2359296
    buffer_load_dword v191, v14, s[24:27], s63 offen
    s_add_u32 s63, s63, 8192
    buffer_load_dword v191, v14, s[24:27], s63 offen
PF3:
    s_mul_i32 s62, s57, 49152
    s_movk_i32 s63, 6144
    v_mad_u32_u24 v9, v4, s63, v3
    v_add_u32 v9, s62, v9
    s_lshl_b32 s62, s57, 10
    s_add_u32 s62, s62, 147456
    v_lshl_add_u32 v10, v4, 7, s62
    ds_read_b128 v[136:139], v10 offset:2048
    ds_read_b128 v[140:143], v10 offset:2064
    ds_read_b128 v[144:147], v10 offset:0
    ds_read_b128 v[148:151], v10 offset:16
    ds_read_b128 v[152:155], v10 offset:2080
    ds_read_b128 v[156:159], v10 offset:2096
    ds_read_b128 v[160:163], v10 offset:32
    ds_read_b128 v[164:167], v10 offset:48
    ds_read_b64_tr_b16 a[0:1], v9 offset:1024
    ds_read_b64_tr_b16 a[2:3], v9 offset:1280
    ds_read_b64_tr_b16 a[4:5], v9 offset:2048
    ds_read_b64_tr_b16 a[6:7], v9 offset:2304
    ds_read_b64_tr_b16 a[8:9], v9 offset:1536
    ds_read_b64_tr_b16 a[10:11], v9 offset:1792
    ds_read_b64_tr_b16 a[12:13], v9 offset:2560
    ds_read_b64_tr_b16 a[14:15], v9 offset:2816
    s_waitcnt lgkmcnt(15)
    v_add_f32 v176, v176, v180
    v_add_f32 v177, v177, v181
    v_mul_f32 v176, 0x3b000000, v176
    v_mul_f32 v177, 0x3b000000, v177
    v_fma_f32 v178, -v176, v176, v177
    v_max_f32 v178, 0, v178
    v_add_f32 v178, 0x3727c5ac, v178
    v_rsq_f32 v7, v178
    s_nop 0
    v_mul_f32_e64 v8, -v176, v7
    s_waitcnt lgkmcnt(12)
    v_lshlrev_b32 v168, 16, v24
    v_and_b32 v169, 0xffff0000, v24
    v_lshlrev_b32 v170, 16, v25
    v_and_b32 v171, 0xffff0000, v25
    v_lshlrev_b32 v172, 16, v26
    v_and_b32 v173, 0xffff0000, v26
    v_lshlrev_b32 v174, 16, v27
    v_and_b32 v175, 0xffff0000, v27
    v_fma_f32 v168, v168, v7, v8
    v_fma_f32 v169, v169, v7, v8
    v_fma_f32 v170, v170, v7, v8
    v_fma_f32 v171, v171, v7, v8
    v_fma_f32 v172, v172, v7, v8
    v_fma_f32 v173, v173, v7, v8
    v_fma_f32 v174, v174, v7, v8
    v_fma_f32 v175, v175, v7, v8
    v_fma_f32 v168, v168, v136, v144
    v_fma_f32 v169, v169, v137, v145
    v_fma_f32 v170, v170, v138, v146
    v_fma_f32 v171, v171, v139, v147
    v_fma_f32 v172, v172, v140, v148
    v_fma_f32 v173, v173, v141, v149
    v_fma_f32 v174, v174, v142, v150
    v_fma_f32 v175, v175, v143, v151
    v_cvt_pk_bf16_f32 v24, v168, v169
    v_cvt_pk_bf16_f32 v25, v170, v171
    v_cvt_pk_bf16_f32 v26, v172, v173
    v_cvt_pk_bf16_f32 v27, v174, v175
    ds_read_b128 v[136:139], v10 offset:2112
    ds_read_b128 v[140:143], v10 offset:2128
    ds_read_b128 v[144:147], v10 offset:64
    ds_read_b128 v[148:151], v10 offset:80
    ds_read_b64_tr_b16 a[16:17], v9 offset:4096
    ds_read_b64_tr_b16 a[18:19], v9 offset:4352
    ds_read_b64_tr_b16 a[20:21], v9 offset:5120
    ds_read_b64_tr_b16 a[22:23], v9 offset:5376
    s_waitcnt lgkmcnt(8)
    v_mfma_f32_32x32x16_bf16 v[88:103], a[0:3], v[24:27], 0
    v_lshlrev_b32 v168, 16, v28
    v_and_b32 v169, 0xffff0000, v28
    v_lshlrev_b32 v170, 16, v29
    v_and_b32 v171, 0xffff0000, v29
    v_lshlrev_b32 v172, 16, v30
    v_and_b32 v173, 0xffff0000, v30
    v_lshlrev_b32 v174, 16, v31
    v_and_b32 v175, 0xffff0000, v31
    v_fma_f32 v168, v168, v7, v8
    v_fma_f32 v169, v169, v7, v8
    v_fma_f32 v170, v170, v7, v8
    v_fma_f32 v171, v171, v7, v8
    v_fma_f32 v172, v172, v7, v8
    v_fma_f32 v173, v173, v7, v8
    v_mfma_f32_32x32x16_bf16 v[104:119], v[24:27], a[4:7], 0
    v_fma_f32 v174, v174, v7, v8
    v_fma_f32 v175, v175, v7, v8
    v_fma_f32 v168, v168, v152, v160
    v_fma_f32 v169, v169, v153, v161
    v_fma_f32 v170, v170, v154, v162
    v_fma_f32 v171, v171, v155, v163
    v_fma_f32 v172, v172, v156, v164
    v_fma_f32 v173, v173, v157, v165
    v_fma_f32 v174, v174, v158, v166
    v_fma_f32 v175, v175, v159, v167
    v_cvt_pk_bf16_f32 v28, v168, v169
    v_cvt_pk_bf16_f32 v29, v170, v171
    v_cvt_pk_bf16_f32 v30, v172, v173
    v_cvt_pk_bf16_f32 v31, v174, v175
    ds_read_b128 v[152:155], v10 offset:2144
    ds_read_b128 v[156:159], v10 offset:2160
    ds_read_b128 v[160:163], v10 offset:96
    ds_read_b128 v[164:167], v10 offset:112
    ds_read_b64_tr_b16 a[24:25], v9 offset:4608
    ds_read_b64_tr_b16 a[26:27], v9 offset:4864
    ds_read_b64_tr_b16 a[28:29], v9 offset:5632
    ds_read_b64_tr_b16 a[30:31], v9 offset:5888
    s_waitcnt lgkmcnt(8)
    v_mfma_f32_32x32x16_bf16 v[88:103], a[8:11], v[28:31], v[88:103]
    v_lshlrev_b32 v168, 16, v32
    v_and_b32 v169, 0xffff0000, v32
    v_lshlrev_b32 v170, 16, v33
    v_and_b32 v171, 0xffff0000, v33
    v_lshlrev_b32 v172, 16, v34
    v_and_b32 v173, 0xffff0000, v34
    v_lshlrev_b32 v174, 16, v35
    v_and_b32 v175, 0xffff0000, v35
    v_fma_f32 v168, v168, v7, v8
    v_fma_f32 v169, v169, v7, v8
    v_fma_f32 v170, v170, v7, v8
    v_fma_f32 v171, v171, v7, v8
    v_fma_f32 v172, v172, v7, v8
    v_fma_f32 v173, v173, v7, v8
    v_mfma_f32_32x32x16_bf16 v[104:119], v[28:31], a[12:15], v[104:119]
    v_fma_f32 v174, v174, v7, v8
    v_fma_f32 v175, v175, v7, v8
    v_fma_f32 v168, v168, v136, v144
    v_fma_f32 v169, v169, v137, v145
    v_fma_f32 v170, v170, v138, v146
    v_fma_f32 v171, v171, v139, v147
    v_fma_f32 v172, v172, v140, v148
    v_fma_f32 v173, v173, v141, v149
    v_fma_f32 v174, v174, v142, v150
    v_fma_f32 v175, v175, v143, v151
    v_cvt_pk_bf16_f32 v32, v168, v169
    v_cvt_pk_bf16_f32 v33, v170, v171
    v_cvt_pk_bf16_f32 v34, v172, v173
    v_cvt_pk_bf16_f32 v35, v174, v175
    ds_read_b128 v[136:139], v10 offset:2304
    ds_read_b128 v[140:143], v10 offset:2320
    ds_read_b128 v[144:147], v10 offset:256
    ds_read_b128 v[148:151], v10 offset:272
    ds_read_b64_tr_b16 a[0:1], v9 offset:13312
    ds_read_b64_tr_b16 a[2:3], v9 offset:13568
    ds_read_b64_tr_b16 a[4:5], v9 offset:14336
    ds_read_b64_tr_b16 a[6:7], v9 offset:14592
    s_waitcnt lgkmcnt(8)
    v_mfma_f32_32x32x16_bf16 v[88:103], a[16:19], v[32:35], v[88:103]
    v_lshlrev_b32 v168, 16, v36
    v_and_b32 v169, 0xffff0000, v36
    v_lshlrev_b32 v170, 16, v37
    v_and_b32 v171, 0xffff0000, v37
    v_lshlrev_b32 v172, 16, v38
    v_and_b32 v173, 0xffff0000, v38
    v_lshlrev_b32 v174, 16, v39
    v_and_b32 v175, 0xffff0000, v39
    v_fma_f32 v168, v168, v7, v8
    v_fma_f32 v169, v169, v7, v8
    v_fma_f32 v170, v170, v7, v8
    v_fma_f32 v171, v171, v7, v8
    v_fma_f32 v172, v172, v7, v8
    v_fma_f32 v173, v173, v7, v8
    v_mfma_f32_32x32x16_bf16 v[104:119], v[32:35], a[20:23], v[104:119]
    v_fma_f32 v174, v174, v7, v8
    v_fma_f32 v175, v175, v7, v8
    v_fma_f32 v168, v168, v152, v160
    v_fma_f32 v169, v169, v153, v161
    v_fma_f32 v170, v170, v154, v162
    v_fma_f32 v171, v171, v155, v163
    v_fma_f32 v172, v172, v156, v164
    v_fma_f32 v173, v173, v157, v165
    v_fma_f32 v174, v174, v158, v166
    v_fma_f32 v175, v175, v159, v167
    v_cvt_pk_bf16_f32 v36, v168, v169
    v_cvt_pk_bf16_f32 v37, v170, v171
    v_cvt_pk_bf16_f32 v38, v172, v173
    v_cvt_pk_bf16_f32 v39, v174, v175
    ds_read_b128 v[152:155], v10 offset:2336
    ds_read_b128 v[156:159], v10 offset:2352
    ds_read_b128 v[160:163], v10 offset:288
    ds_read_b128 v[164:167], v10 offset:304
    ds_read_b64_tr_b16 a[8:9], v9 offset:13824
    ds_read_b64_tr_b16 a[10:11], v9 offset:14080
    ds_read_b64_tr_b16 a[12:13], v9 offset:14848
    ds_read_b64_tr_b16 a[14:15], v9 offset:15104
    s_waitcnt lgkmcnt(8)
    v_mfma_f32_32x32x16_bf16 v[88:103], a[24:27], v[36:39], v[88:103]
    v_lshlrev_b32 v168, 16, v40
    v_and_b32 v169, 0xffff0000, v40
    v_lshlrev_b32 v170, 16, v41
    v_and_b32 v171, 0xffff0000, v41
    v_lshlrev_b32 v172, 16, v42
    v_and_b32 v173, 0xffff0000, v42
    v_lshlrev_b32 v174, 16, v43
    v_and_b32 v175, 0xffff0000, v43
    v_fma_f32 v168, v168, v7, v8
    v_fma_f32 v169, v169, v7, v8
    v_fma_f32 v170, v170, v7, v8
    v_fma_f32 v171, v171, v7, v8
    v_fma_f32 v172, v172, v7, v8
    v_fma_f32 v173, v173, v7, v8
    v_mfma_f32_32x32x16_bf16 v[104:119], v[36:39], a[28:31], v[104:119]
    v_fma_f32 v174, v174, v7, v8
    v_fma_f32 v175, v175, v7, v8
    v_fma_f32 v168, v168, v136, v144
    v_fma_f32 v169, v169, v137, v145
    v_fma_f32 v170, v170, v138, v146
    v_fma_f32 v171, v171, v139, v147
    v_fma_f32 v172, v172, v140, v148
    v_fma_f32 v173, v173, v141, v149
    v_fma_f32 v174, v174, v142, v150
    v_fma_f32 v175, v175, v143, v151
    v_cvt_pk_bf16_f32 v40, v168, v169
    v_cvt_pk_bf16_f32 v41, v170, v171
    v_cvt_pk_bf16_f32 v42, v172, v173
    v_cvt_pk_bf16_f32 v43, v174, v175
    ds_read_b128 v[136:139], v10 offset:2368
    ds_read_b128 v[140:143], v10 offset:2384
    ds_read_b128 v[144:147], v10 offset:320
    ds_read_b128 v[148:151], v10 offset:336
    ds_read_b64_tr_b16 a[16:17], v9 offset:16384
    ds_read_b64_tr_b16 a[18:19], v9 offset:16640
    ds_read_b64_tr_b16 a[20:21], v9 offset:17408
    ds_read_b64_tr_b16 a[22:23], v9 offset:17664
    s_waitcnt lgkmcnt(8)
    v_mfma_f32_32x32x16_bf16 v[88:103], a[0:3], v[40:43], v[88:103]
    v_lshlrev_b32 v168, 16, v44
    v_and_b32 v169, 0xffff0000, v44
    v_lshlrev_b32 v170, 16, v45
    v_and_b32 v171, 0xffff0000, v45
    v_lshlrev_b32 v172, 16, v46
    v_and_b32 v173, 0xffff0000, v46
    v_lshlrev_b32 v174, 16, v47
    v_and_b32 v175, 0xffff0000, v47
    v_fma_f32 v168, v168, v7, v8
    v_fma_f32 v169, v169, v7, v8
    v_fma_f32 v170, v170, v7, v8
    v_fma_f32 v171, v171, v7, v8
    v_fma_f32 v172, v172, v7, v8
    v_fma_f32 v173, v173, v7, v8
    v_mfma_f32_32x32x16_bf16 v[104:119], v[40:43], a[4:7], v[104:119]
    v_fma_f32 v174, v174, v7, v8
    v_fma_f32 v175, v175, v7, v8
    v_fma_f32 v168, v168, v152, v160
    v_fma_f32 v169, v169, v153, v161
    v_fma_f32 v170, v170, v154, v162
    v_fma_f32 v171, v171, v155, v163
    v_fma_f32 v172, v172, v156, v164
    v_fma_f32 v173, v173, v157, v165
    v_fma_f32 v174, v174, v158, v166
    v_fma_f32 v175, v175, v159, v167
    v_cvt_pk_bf16_f32 v44, v168, v169
    v_cvt_pk_bf16_f32 v45, v170, v171
    v_cvt_pk_bf16_f32 v46, v172, v173
    v_cvt_pk_bf16_f32 v47, v174, v175
    ds_read_b128 v[152:155], v10 offset:2400
    ds_read_b128 v[156:159], v10 offset:2416
    ds_read_b128 v[160:163], v10 offset:352
    ds_read_b128 v[164:167], v10 offset:368
    ds_read_b64_tr_b16 a[24:25], v9 offset:16896
    ds_read_b64_tr_b16 a[26:27], v9 offset:17152
    ds_read_b64_tr_b16 a[28:29], v9 offset:17920
    ds_read_b64_tr_b16 a[30:31], v9 offset:18176
    s_waitcnt lgkmcnt(8)
    v_mfma_f32_32x32x16_bf16 v[88:103], a[8:11], v[44:47], v[88:103]
    v_lshlrev_b32 v168, 16, v48
    v_and_b32 v169, 0xffff0000, v48
    v_lshlrev_b32 v170, 16, v49
    v_and_b32 v171, 0xffff0000, v49
    v_lshlrev_b32 v172, 16, v50
    v_and_b32 v173, 0xffff0000, v50
    v_lshlrev_b32 v174, 16, v51
    v_and_b32 v175, 0xffff0000, v51
    v_fma_f32 v168, v168, v7, v8
    v_fma_f32 v169, v169, v7, v8
    v_fma_f32 v170, v170, v7, v8
    v_fma_f32 v171, v171, v7, v8
    v_fma_f32 v172, v172, v7, v8
    v_fma_f32 v173, v173, v7, v8
    v_mfma_f32_32x32x16_bf16 v[104:119], v[44:47], a[12:15], v[104:119]
    v_fma_f32 v174, v174, v7, v8
    v_fma_f32 v175, v175, v7, v8
    v_fma_f32 v168, v168, v136, v144
    v_fma_f32 v169, v169, v137, v145
    v_fma_f32 v170, v170, v138, v146
    v_fma_f32 v171, v171, v139, v147
    v_fma_f32 v172, v172, v140, v148
    v_fma_f32 v173, v173, v141, v149
    v_fma_f32 v174, v174, v142, v150
    v_fma_f32 v175, v175, v143, v151
    v_cvt_pk_bf16_f32 v48, v168, v169
    v_cvt_pk_bf16_f32 v49, v170, v171
    v_cvt_pk_bf16_f32 v50, v172, v173
    v_cvt_pk_bf16_f32 v51, v174, v175
    ds_read_b128 v[136:139], v10 offset:2560
    ds_read_b128 v[140:143], v10 offset:2576
    ds_read_b128 v[144:147], v10 offset:512
    ds_read_b128 v[148:151], v10 offset:528
    ds_read_b64_tr_b16 a[0:1], v9 offset:25600
    ds_read_b64_tr_b16 a[2:3], v9 offset:25856
    ds_read_b64_tr_b16 a[4:5], v9 offset:26624
    ds_read_b64_tr_b16 a[6:7], v9 offset:26880
    s_waitcnt lgkmcnt(8)
    v_mfma_f32_32x32x16_bf16 v[88:103], a[16:19], v[48:51], v[88:103]
    v_lshlrev_b32 v168, 16, v52
    v_and_b32 v169, 0xffff0000, v52
    v_lshlrev_b32 v170, 16, v53
    v_and_b32 v171, 0xffff0000, v53
    v_lshlrev_b32 v172, 16, v54
    v_and_b32 v173, 0xffff0000, v54
    v_lshlrev_b32 v174, 16, v55
    v_and_b32 v175, 0xffff0000, v55
    v_fma_f32 v168, v168, v7, v8
    v_fma_f32 v169, v169, v7, v8
    v_fma_f32 v170, v170, v7, v8
    v_fma_f32 v171, v171, v7, v8
    v_fma_f32 v172, v172, v7, v8
    v_fma_f32 v173, v173, v7, v8
    v_mfma_f32_32x32x16_bf16 v[104:119], v[48:51], a[20:23], v[104:119]
    v_fma_f32 v174, v174, v7, v8
    v_fma_f32 v175, v175, v7, v8
    v_fma_f32 v168, v168, v152, v160
    v_fma_f32 v169, v169, v153, v161
    v_fma_f32 v170, v170, v154, v162
    v_fma_f32 v171, v171, v155, v163
    v_fma_f32 v172, v172, v156, v164
    v_fma_f32 v173, v173, v157, v165
    v_fma_f32 v174, v174, v158, v166
    v_fma_f32 v175, v175, v159, v167
    v_cvt_pk_bf16_f32 v52, v168, v169
    v_cvt_pk_bf16_f32 v53, v170, v171
    v_cvt_pk_bf16_f32 v54, v172, v173
    v_cvt_pk_bf16_f32 v55, v174, v175
    ds_read_b128 v[152:155], v10 offset:2592
    ds_read_b128 v[156:159], v10 offset:2608
    ds_read_b128 v[160:163], v10 offset:544
    ds_read_b128 v[164:167], v10 offset:560
    ds_read_b64_tr_b16 a[8:9], v9 offset:26112
    ds_read_b64_tr_b16 a[10:11], v9 offset:26368
    ds_read_b64_tr_b16 a[12:13], v9 offset:27136
    ds_read_b64_tr_b16 a[14:15], v9 offset:27392
    s_waitcnt lgkmcnt(8)
    v_mfma_f32_32x32x16_bf16 v[88:103], a[24:27], v[52:55], v[88:103]
    v_lshlrev_b32 v168, 16, v56
    v_and_b32 v169, 0xffff0000, v56
    v_lshlrev_b32 v170, 16, v57
    v_and_b32 v171, 0xffff0000, v57
    v_lshlrev_b32 v172, 16, v58
    v_and_b32 v173, 0xffff0000, v58
    v_lshlrev_b32 v174, 16, v59
    v_and_b32 v175, 0xffff0000, v59
    v_fma_f32 v168, v168, v7, v8
    v_fma_f32 v169, v169, v7, v8
    v_fma_f32 v170, v170, v7, v8
    v_fma_f32 v171, v171, v7, v8
    v_fma_f32 v172, v172, v7, v8
    v_fma_f32 v173, v173, v7, v8
    v_mfma_f32_32x32x16_bf16 v[104:119], v[52:55], a[28:31], v[104:119]
    v_fma_f32 v174, v174, v7, v8
    v_fma_f32 v175, v175, v7, v8
    v_fma_f32 v168, v168, v136, v144
    v_fma_f32 v169, v169, v137, v145
    v_fma_f32 v170, v170, v138, v146
    v_fma_f32 v171, v171, v139, v147
    v_fma_f32 v172, v172, v140, v148
    v_fma_f32 v173, v173, v141, v149
    v_fma_f32 v174, v174, v142, v150
    v_fma_f32 v175, v175, v143, v151
    v_cvt_pk_bf16_f32 v56, v168, v169
    v_cvt_pk_bf16_f32 v57, v170, v171
    v_cvt_pk_bf16_f32 v58, v172, v173
    v_cvt_pk_bf16_f32 v59, v174, v175
    ds_read_b128 v[136:139], v10 offset:2624
    ds_read_b128 v[140:143], v10 offset:2640
    ds_read_b128 v[144:147], v10 offset:576
    ds_read_b128 v[148:151], v10 offset:592
    ds_read_b64_tr_b16 a[16:17], v9 offset:28672
    ds_read_b64_tr_b16 a[18:19], v9 offset:28928
    ds_read_b64_tr_b16 a[20:21], v9 offset:29696
    ds_read_b64_tr_b16 a[22:23], v9 offset:29952
    s_waitcnt lgkmcnt(8)
    v_mfma_f32_32x32x16_bf16 v[88:103], a[0:3], v[56:59], v[88:103]
    v_lshlrev_b32 v168, 16, v60
    v_and_b32 v169, 0xffff0000, v60
    v_lshlrev_b32 v170, 16, v61
    v_and_b32 v171, 0xffff0000, v61
    v_lshlrev_b32 v172, 16, v62
    v_and_b32 v173, 0xffff0000, v62
    v_lshlrev_b32 v174, 16, v63
    v_and_b32 v175, 0xffff0000, v63
    v_fma_f32 v168, v168, v7, v8
    v_fma_f32 v169, v169, v7, v8
    v_fma_f32 v170, v170, v7, v8
    v_fma_f32 v171, v171, v7, v8
    v_fma_f32 v172, v172, v7, v8
    v_fma_f32 v173, v173, v7, v8
    v_mfma_f32_32x32x16_bf16 v[104:119], v[56:59], a[4:7], v[104:119]
    v_fma_f32 v174, v174, v7, v8
    v_fma_f32 v175, v175, v7, v8
    v_fma_f32 v168, v168, v152, v160
    v_fma_f32 v169, v169, v153, v161
    v_fma_f32 v170, v170, v154, v162
    v_fma_f32 v171, v171, v155, v163
    v_fma_f32 v172, v172, v156, v164
    v_fma_f32 v173, v173, v157, v165
    v_fma_f32 v174, v174, v158, v166
    v_fma_f32 v175, v175, v159, v167
    v_cvt_pk_bf16_f32 v60, v168, v169
    v_cvt_pk_bf16_f32 v61, v170, v171
    v_cvt_pk_bf16_f32 v62, v172, v173
    v_cvt_pk_bf16_f32 v63, v174, v175
    ds_read_b128 v[152:155], v10 offset:2656
    ds_read_b128 v[156:159], v10 offset:2672
    ds_read_b128 v[160:163], v10 offset:608
    ds_read_b128 v[164:167], v10 offset:624
    ds_read_b64_tr_b16 a[24:25], v9 offset:29184
    ds_read_b64_tr_b16 a[26:27], v9 offset:29440
    ds_read_b64_tr_b16 a[28:29], v9 offset:30208
    ds_read_b64_tr_b16 a[30:31], v9 offset:30464
    s_waitcnt lgkmcnt(8)
    v_mfma_f32_32x32x16_bf16 v[88:103], a[8:11], v[60:63], v[88:103]
    v_lshlrev_b32 v168, 16, v64
    v_and_b32 v169, 0xffff0000, v64
    v_lshlrev_b32 v170, 16, v65
    v_and_b32 v171, 0xffff0000, v65
    v_lshlrev_b32 v172, 16, v66
    v_and_b32 v173, 0xffff0000, v66
    v_lshlrev_b32 v174, 16, v67
    v_and_b32 v175, 0xffff0000, v67
    v_fma_f32 v168, v168, v7, v8
    v_fma_f32 v169, v169, v7, v8
    v_fma_f32 v170, v170, v7, v8
    v_fma_f32 v171, v171, v7, v8
    v_fma_f32 v172, v172, v7, v8
    v_fma_f32 v173, v173, v7, v8
    v_mfma_f32_32x32x16_bf16 v[104:119], v[60:63], a[12:15], v[104:119]
    v_fma_f32 v174, v174, v7, v8
    v_fma_f32 v175, v175, v7, v8
    v_fma_f32 v168, v168, v136, v144
    v_fma_f32 v169, v169, v137, v145
    v_fma_f32 v170, v170, v138, v146
    v_fma_f32 v171, v171, v139, v147
    v_fma_f32 v172, v172, v140, v148
    v_fma_f32 v173, v173, v141, v149
    v_fma_f32 v174, v174, v142, v150
    v_fma_f32 v175, v175, v143, v151
    v_cvt_pk_bf16_f32 v64, v168, v169
    v_cvt_pk_bf16_f32 v65, v170, v171
    v_cvt_pk_bf16_f32 v66, v172, v173
    v_cvt_pk_bf16_f32 v67, v174, v175
    ds_read_b128 v[136:139], v10 offset:2816
    ds_read_b128 v[140:143], v10 offset:2832
    ds_read_b128 v[144:147], v10 offset:768
    ds_read_b128 v[148:151], v10 offset:784
    ds_read_b64_tr_b16 a[0:1], v9 offset:37888
    ds_read_b64_tr_b16 a[2:3], v9 offset:38144
    ds_read_b64_tr_b16 a[4:5], v9 offset:38912
    ds_read_b64_tr_b16 a[6:7], v9 offset:39168
    s_waitcnt lgkmcnt(8)
    v_mfma_f32_32x32x16_bf16 v[88:103], a[16:19], v[64:67], v[88:103]
    v_lshlrev_b32 v168, 16, v68
    v_and_b32 v169, 0xffff0000, v68
    v_lshlrev_b32 v170, 16, v69
    v_and_b32 v171, 0xffff0000, v69
    v_lshlrev_b32 v172, 16, v70
    v_and_b32 v173, 0xffff0000, v70
    v_lshlrev_b32 v174, 16, v71
    v_and_b32 v175, 0xffff0000, v71
    v_fma_f32 v168, v168, v7, v8
    v_fma_f32 v169, v169, v7, v8
    v_fma_f32 v170, v170, v7, v8
    v_fma_f32 v171, v171, v7, v8
    v_fma_f32 v172, v172, v7, v8
    v_fma_f32 v173, v173, v7, v8
    v_mfma_f32_32x32x16_bf16 v[104:119], v[64:67], a[20:23], v[104:119]
    v_fma_f32 v174, v174, v7, v8
    v_fma_f32 v175, v175, v7, v8
    v_fma_f32 v168, v168, v152, v160
    v_fma_f32 v169, v169, v153, v161
    v_fma_f32 v170, v170, v154, v162
    v_fma_f32 v171, v171, v155, v163
    v_fma_f32 v172, v172, v156, v164
    v_fma_f32 v173, v173, v157, v165
    v_fma_f32 v174, v174, v158, v166
    v_fma_f32 v175, v175, v159, v167
    v_cvt_pk_bf16_f32 v68, v168, v169
    v_cvt_pk_bf16_f32 v69, v170, v171
    v_cvt_pk_bf16_f32 v70, v172, v173
    v_cvt_pk_bf16_f32 v71, v174, v175
    ds_read_b128 v[152:155], v10 offset:2848
    ds_read_b128 v[156:159], v10 offset:2864
    ds_read_b128 v[160:163], v10 offset:800
    ds_read_b128 v[164:167], v10 offset:816
    ds_read_b64_tr_b16 a[8:9], v9 offset:38400
    ds_read_b64_tr_b16 a[10:11], v9 offset:38656
    ds_read_b64_tr_b16 a[12:13], v9 offset:39424
    ds_read_b64_tr_b16 a[14:15], v9 offset:39680
    s_waitcnt lgkmcnt(8)
    v_mfma_f32_32x32x16_bf16 v[88:103], a[24:27], v[68:71], v[88:103]
    v_lshlrev_b32 v168, 16, v72
    v_and_b32 v169, 0xffff0000, v72
    v_lshlrev_b32 v170, 16, v73
    v_and_b32 v171, 0xffff0000, v73
    v_lshlrev_b32 v172, 16, v74
    v_and_b32 v173, 0xffff0000, v74
    v_lshlrev_b32 v174, 16, v75
    v_and_b32 v175, 0xffff0000, v75
    v_fma_f32 v168, v168, v7, v8
    v_fma_f32 v169, v169, v7, v8
    v_fma_f32 v170, v170, v7, v8
    v_fma_f32 v171, v171, v7, v8
    v_fma_f32 v172, v172, v7, v8
    v_fma_f32 v173, v173, v7, v8
    v_mfma_f32_32x32x16_bf16 v[104:119], v[68:71], a[28:31], v[104:119]
    v_fma_f32 v174, v174, v7, v8
    v_fma_f32 v175, v175, v7, v8
    v_fma_f32 v168, v168, v136, v144
    v_fma_f32 v169, v169, v137, v145
    v_fma_f32 v170, v170, v138, v146
    v_fma_f32 v171, v171, v139, v147
    v_fma_f32 v172, v172, v140, v148
    v_fma_f32 v173, v173, v141, v149
    v_fma_f32 v174, v174, v142, v150
    v_fma_f32 v175, v175, v143, v151
    v_cvt_pk_bf16_f32 v72, v168, v169
    v_cvt_pk_bf16_f32 v73, v170, v171
    v_cvt_pk_bf16_f32 v74, v172, v173
    v_cvt_pk_bf16_f32 v75, v174, v175
    ds_read_b128 v[136:139], v10 offset:2880
    ds_read_b128 v[140:143], v10 offset:2896
    ds_read_b128 v[144:147], v10 offset:832
    ds_read_b128 v[148:151], v10 offset:848
    ds_read_b64_tr_b16 a[16:17], v9 offset:40960
    ds_read_b64_tr_b16 a[18:19], v9 offset:41216
    ds_read_b64_tr_b16 a[20:21], v9 offset:41984
    ds_read_b64_tr_b16 a[22:23], v9 offset:42240
    s_waitcnt lgkmcnt(8)
    v_mfma_f32_32x32x16_bf16 v[88:103], a[0:3], v[72:75], v[88:103]
    v_lshlrev_b32 v168, 16, v76
    v_and_b32 v169, 0xffff0000, v76
    v_lshlrev_b32 v170, 16, v77
    v_and_b32 v171, 0xffff0000, v77
    v_lshlrev_b32 v172, 16, v78
    v_and_b32 v173, 0xffff0000, v78
    v_lshlrev_b32 v174, 16, v79
    v_and_b32 v175, 0xffff0000, v79
    v_fma_f32 v168, v168, v7, v8
    v_fma_f32 v169, v169, v7, v8
    v_fma_f32 v170, v170, v7, v8
    v_fma_f32 v171, v171, v7, v8
    v_fma_f32 v172, v172, v7, v8
    v_fma_f32 v173, v173, v7, v8
    v_mfma_f32_32x32x16_bf16 v[104:119], v[72:75], a[4:7], v[104:119]
    v_fma_f32 v174, v174, v7, v8
    v_fma_f32 v175, v175, v7, v8
    v_fma_f32 v168, v168, v152, v160
    v_fma_f32 v169, v169, v153, v161
    v_fma_f32 v170, v170, v154, v162
    v_fma_f32 v171, v171, v155, v163
    v_fma_f32 v172, v172, v156, v164
    v_fma_f32 v173, v173, v157, v165
    v_fma_f32 v174, v174, v158, v166
    v_fma_f32 v175, v175, v159, v167
    v_cvt_pk_bf16_f32 v76, v168, v169
    v_cvt_pk_bf16_f32 v77, v170, v171
    v_cvt_pk_bf16_f32 v78, v172, v173
    v_cvt_pk_bf16_f32 v79, v174, v175
    ds_read_b128 v[152:155], v10 offset:2912
    ds_read_b128 v[156:159], v10 offset:2928
    ds_read_b128 v[160:163], v10 offset:864
    ds_read_b128 v[164:167], v10 offset:880
    ds_read_b64_tr_b16 a[24:25], v9 offset:41472
    ds_read_b64_tr_b16 a[26:27], v9 offset:41728
    ds_read_b64_tr_b16 a[28:29], v9 offset:42496
    ds_read_b64_tr_b16 a[30:31], v9 offset:42752
    s_waitcnt lgkmcnt(8)
    v_mfma_f32_32x32x16_bf16 v[88:103], a[8:11], v[76:79], v[88:103]
    v_lshlrev_b32 v168, 16, v80
    v_and_b32 v169, 0xffff0000, v80
    v_lshlrev_b32 v170, 16, v81
    v_and_b32 v171, 0xffff0000, v81
    v_lshlrev_b32 v172, 16, v82
    v_and_b32 v173, 0xffff0000, v82
    v_lshlrev_b32 v174, 16, v83
    v_and_b32 v175, 0xffff0000, v83
    v_fma_f32 v168, v168, v7, v8
    v_fma_f32 v169, v169, v7, v8
    v_fma_f32 v170, v170, v7, v8
    v_fma_f32 v171, v171, v7, v8
    v_fma_f32 v172, v172, v7, v8
    v_fma_f32 v173, v173, v7, v8
    v_mfma_f32_32x32x16_bf16 v[104:119], v[76:79], a[12:15], v[104:119]
    v_fma_f32 v174, v174, v7, v8
    v_fma_f32 v175, v175, v7, v8
    v_fma_f32 v168, v168, v136, v144
    v_fma_f32 v169, v169, v137, v145
    v_fma_f32 v170, v170, v138, v146
    v_fma_f32 v171, v171, v139, v147
    v_fma_f32 v172, v172, v140, v148
    v_fma_f32 v173, v173, v141, v149
    v_fma_f32 v174, v174, v142, v150
    v_fma_f32 v175, v175, v143, v151
    v_cvt_pk_bf16_f32 v80, v168, v169
    v_cvt_pk_bf16_f32 v81, v170, v171
    v_cvt_pk_bf16_f32 v82, v172, v173
    v_cvt_pk_bf16_f32 v83, v174, v175
    s_waitcnt lgkmcnt(0)
    s_nop 0
    v_mfma_f32_32x32x16_bf16 v[88:103], a[16:19], v[80:83], v[88:103]
    v_lshlrev_b32 v168, 16, v84
    v_and_b32 v169, 0xffff0000, v84
    v_lshlrev_b32 v170, 16, v85
    v_and_b32 v171, 0xffff0000, v85
    v_lshlrev_b32 v172, 16, v86
    v_and_b32 v173, 0xffff0000, v86
    v_lshlrev_b32 v174, 16, v87
    v_and_b32 v175, 0xffff0000, v87
    v_fma_f32 v168, v168, v7, v8
    v_fma_f32 v169, v169, v7, v8
    v_fma_f32 v170, v170, v7, v8
    v_fma_f32 v171, v171, v7, v8
    v_fma_f32 v172, v172, v7, v8
    v_fma_f32 v173, v173, v7, v8
    v_mfma_f32_32x32x16_bf16 v[104:119], v[80:83], a[20:23], v[104:119]
    v_fma_f32 v174, v174, v7, v8
    v_fma_f32 v175, v175, v7, v8
    v_fma_f32 v168, v168, v152, v160
    v_fma_f32 v169, v169, v153, v161
    v_fma_f32 v170, v170, v154, v162
    v_fma_f32 v171, v171, v155, v163
    v_fma_f32 v172, v172, v156, v164
    v_fma_f32 v173, v173, v157, v165
    v_fma_f32 v174, v174, v158, v166
    v_fma_f32 v175, v175, v159, v167
    v_cvt_pk_bf16_f32 v84, v168, v169
    v_cvt_pk_bf16_f32 v85, v170, v171
    v_cvt_pk_bf16_f32 v86, v172, v173
    v_cvt_pk_bf16_f32 v87, v174, v175
    s_nop 1
    v_mfma_f32_32x32x16_bf16 v[88:103], a[24:27], v[84:87], v[88:103]
    v_mfma_f32_32x32x16_bf16 v[104:119], v[84:87], a[28:31], v[104:119]
    ds_read_b64_tr_b16 a[0:1], v9 offset:0
    ds_read_b64_tr_b16 a[2:3], v9 offset:256
    ds_read_b64_tr_b16 a[4:5], v9 offset:512
    ds_read_b64_tr_b16 a[6:7], v9 offset:768
    ds_read_b64_tr_b16 a[8:9], v9 offset:3072
    ds_read_b64_tr_b16 a[10:11], v9 offset:3328
    ds_read_b64_tr_b16 a[12:13], v9 offset:3584
    ds_read_b64_tr_b16 a[14:15], v9 offset:3840
    s_lshl_b32 s62, s56, 12
    v_add_u32 v11, s62, v2
    s_cmp_eq_u32 s57, 0
    s_cselect_b32 s62, 24576, 0
    s_cselect_b32 s63, 0, 24576
    v_add_u32 v11, 98304, v11
    v_add_u32 v12, s62, v11
    v_add_u32 v11, s63, v11
    s_cbranch_scc1 KVR0
    ds_write_b128 v12, v[88:91] offset:0
    ds_write_b128 v12, v[92:95] offset:1024
    ds_write_b128 v12, v[96:99] offset:2048
    ds_write_b128 v12, v[100:103] offset:3072
    v_mov_b32 v88, v104
    v_mov_b32 v89, v105
    v_mov_b32 v90, v106
    v_mov_b32 v91, v107
    v_mov_b32 v92, v108
    v_mov_b32 v93, v109
    v_mov_b32 v94, v110
    v_mov_b32 v95, v111
    v_mov_b32 v96, v112
    v_mov_b32 v97, v113
    v_mov_b32 v98, v114
    v_mov_b32 v99, v115
    v_mov_b32 v100, v116
    v_mov_b32 v101, v117
    v_mov_b32 v102, v118
    v_mov_b32 v103, v119
    s_branch KVR1
KVR0:
    ds_write_b128 v12, v[104:107] offset:0
    ds_write_b128 v12, v[108:111] offset:1024
    ds_write_b128 v12, v[112:115] offset:2048
    ds_write_b128 v12, v[116:119] offset:3072
KVR1:
    s_waitcnt lgkmcnt(0)
    s_barrier
    ds_read_b128 v[104:107], v11 offset:0
    ds_read_b128 v[108:111], v11 offset:1024
    ds_read_b128 v[112:115], v11 offset:2048
    ds_read_b128 v[116:119], v11 offset:3072
    s_lshl_b32 s62, s53, 4
    s_add_u32 s62, s62, s54
    s_lshl_b32 s98, s62, 14
    s_lshl_b32 s99, s57, 13
    s_add_u32 s98, s98, s99
    s_lshl_b32 s99, s56, 11
    s_add_u32 s98, s98, s99
    s_add_u32 s98, s98, 1048576
    s_add_u32 s63, s63, s99
    s_add_u32 s63, s63, 98304
    v_add_u32 v12, s63, v2
    s_waitcnt lgkmcnt(0)
    v_add_f32 v88, v88, v104
    v_add_f32 v89, v89, v105
    v_add_f32 v90, v90, v106
    v_add_f32 v91, v91, v107
    v_add_f32 v92, v92, v108
    v_add_f32 v93, v93, v109
    v_add_f32 v94, v94, v110
    v_add_f32 v95, v95, v111
    v_add_f32 v96, v96, v112
    v_add_f32 v97, v97, v113
    v_add_f32 v98, v98, v114
    v_add_f32 v99, v99, v115
    v_add_f32 v100, v100, v116
    v_add_f32 v101, v101, v117
    v_add_f32 v102, v102, v118
    v_add_f32 v103, v103, v119
    v_cvt_pk_bf16_f32 v104, v88, v89
    v_cvt_pk_bf16_f32 v105, v90, v91
    v_cvt_pk_bf16_f32 v106, v92, v93
    v_cvt_pk_bf16_f32 v107, v94, v95
    v_cvt_pk_bf16_f32 v108, v96, v97
    v_cvt_pk_bf16_f32 v109, v98, v99
    v_cvt_pk_bf16_f32 v110, v100, v101
    v_cvt_pk_bf16_f32 v111, v102, v103
    buffer_store_dwordx4 v[104:107], v2, s[48:51], s98 offen offset:0 sc1
    buffer_store_dwordx4 v[108:111], v2, s[48:51], s98 offen offset:1024 sc1
    ds_write_b128 v12, v[104:107] offset:16384
    ds_write_b128 v12, v[108:111] offset:17408
    v_mfma_f32_32x32x16_bf16 v[120:135], a[0:3], v[24:27], 0
    ds_read_b64_tr_b16 a[16:17], v9 offset:12288
    ds_read_b64_tr_b16 a[18:19], v9 offset:12544
    v_mfma_f32_32x32x16_bf16 v[120:135], a[4:7], v[28:31], v[120:135]
    ds_read_b64_tr_b16 a[20:21], v9 offset:12800
    ds_read_b64_tr_b16 a[22:23], v9 offset:13056
    v_mfma_f32_32x32x16_bf16 v[120:135], a[8:11], v[32:35], v[120:135]
    ds_read_b64_tr_b16 a[24:25], v9 offset:15360
    ds_read_b64_tr_b16 a[26:27], v9 offset:15616
    v_mfma_f32_32x32x16_bf16 v[120:135], a[12:15], v[36:39], v[120:135]
    ds_read_b64_tr_b16 a[28:29], v9 offset:15872
    ds_read_b64_tr_b16 a[30:31], v9 offset:16128
    s_waitcnt lgkmcnt(6)
    v_mfma_f32_32x32x16_bf16 v[120:135], a[16:19], v[40:43], v[120:135]
    ds_read_b64_tr_b16 a[0:1], v9 offset:24576
    ds_read_b64_tr_b16 a[2:3], v9 offset:24832
    s_waitcnt lgkmcnt(6)
    v_mfma_f32_32x32x16_bf16 v[120:135], a[20:23], v[44:47], v[120:135]
    ds_read_b64_tr_b16 a[4:5], v9 offset:25088
    ds_read_b64_tr_b16 a[6:7], v9 offset:25344
    s_waitcnt lgkmcnt(6)
    v_mfma_f32_32x32x16_bf16 v[120:135], a[24:27], v[48:51], v[120:135]
    ds_read_b64_tr_b16 a[8:9], v9 offset:27648
    ds_read_b64_tr_b16 a[10:11], v9 offset:27904
    s_waitcnt lgkmcnt(6)
    v_mfma_f32_32x32x16_bf16 v[120:135], a[28:31], v[52:55], v[120:135]
    ds_read_b64_tr_b16 a[12:13], v9 offset:28160
    ds_read_b64_tr_b16 a[14:15], v9 offset:28416
    s_waitcnt lgkmcnt(6)
    v_mfma_f32_32x32x16_bf16 v[120:135], a[0:3], v[56:59], v[120:135]
    ds_read_b64_tr_b16 a[16:17], v9 offset:36864
    ds_read_b64_tr_b16 a[18:19], v9 offset:37120
    s_waitcnt lgkmcnt(6)
    v_mfma_f32_32x32x16_bf16 v[120:135], a[4:7], v[60:63], v[120:135]
    ds_read_b64_tr_b16 a[20:21], v9 offset:37376
    ds_read_b64_tr_b16 a[22:23], v9 offset:37632
    s_waitcnt lgkmcnt(6)
    v_mfma_f32_32x32x16_bf16 v[120:135], a[8:11], v[64:67], v[120:135]
    ds_read_b64_tr_b16 a[24:25], v9 offset:39936
    ds_read_b64_tr_b16 a[26:27], v9 offset:40192
    s_waitcnt lgkmcnt(6)
    v_mfma_f32_32x32x16_bf16 v[120:135], a[12:15], v[68:71], v[120:135]
    ds_read_b64_tr_b16 a[28:29], v9 offset:40448
    ds_read_b64_tr_b16 a[30:31], v9 offset:40704
    s_waitcnt lgkmcnt(6)
    v_mfma_f32_32x32x16_bf16 v[120:135], a[16:19], v[72:75], v[120:135]
    s_waitcnt lgkmcnt(4)
    v_mfma_f32_32x32x16_bf16 v[120:135], a[20:23], v[76:79], v[120:135]
    s_waitcnt lgkmcnt(2)
    v_mfma_f32_32x32x16_bf16 v[120:135], a[24:27], v[80:83], v[120:135]
    s_waitcnt lgkmcnt(0)
    v_mfma_f32_32x32x16_bf16 v[120:135], a[28:31], v[84:87], v[120:135]
    s_mul_i32 s63, s52, 3072
    v_add_u32 v11, s63, v2
    s_xor_b32 s63, s52, 4
    s_mul_i32 s63, s63, 3072
    v_add_u32 v13, s63, v2
    s_cmp_eq_u32 s57, 0
    s_cbranch_scc1 QR0
    s_nop 4
    ds_write_b128 v11, v[120:123] offset:1024
    ds_write_b128 v11, v[124:127] offset:2048
    v_mov_b32 v120, v128
    v_mov_b32 v121, v129
    v_mov_b32 v122, v130
    v_mov_b32 v123, v131
    v_mov_b32 v124, v132
    v_mov_b32 v125, v133
    v_mov_b32 v126, v134
    v_mov_b32 v127, v135
    s_branch QR1
QR0:
    s_nop 4
    ds_write_b128 v11, v[128:131] offset:1024
    ds_write_b128 v11, v[132:135] offset:2048
QR1:
    s_lshl_b32 s63, s62, 5
    s_lshl_b32 s99, s52, 2
    s_add_u32 s63, s63, s99
    s_add_u32 s63, s63, 16384
    v_mov_b32 v14, s63
    s_waitcnt vmcnt(0)
    v_mov_b32 v15, s55
    s_mov_b64 exec, 1
    buffer_store_dword v15, v14, s[48:51], 0 offen sc1
    s_mov_b64 exec, -1
    v_cmp_ne_u32 vcc, s3, v188
    v_cmp_ne_u32 s[66:67], s55, v189
    s_nop 0
    s_or_b64 vcc, vcc, s[66:67]
    s_cmp_eq_u64 vcc, 0
    s_cselect_b32 s3, 1, 0
    s_waitcnt lgkmcnt(0)
    s_barrier
    ds_read_b128 v[128:131], v13 offset:1024
    ds_read_b128 v[132:135], v13 offset:2048
    s_waitcnt lgkmcnt(0)
    s_mov_b32 s99, 0x3eb8aa3b
    v_add_f32 v120, v120, v128
    v_add_f32 v121, v121, v129
    v_add_f32 v122, v122, v130
    v_add_f32 v123, v123, v131
    v_add_f32 v124, v124, v132
    v_add_f32 v125, v125, v133
    v_add_f32 v126, v126, v134
    v_add_f32 v127, v127, v135
    v_mul_f32 v120, s99, v120
    v_mul_f32 v121, s99, v121
    v_mul_f32 v122, s99, v122
    v_mul_f32 v123, s99, v123
    v_mul_f32 v124, s99, v124
    v_mul_f32 v125, s99, v125
    v_mul_f32 v126, s99, v126
    v_mul_f32 v127, s99, v127
    v_cvt_pk_bf16_f32 v24, v120, v121
    v_cvt_pk_bf16_f32 v25, v122, v123
    v_cvt_pk_bf16_f32 v26, v124, v125
    v_cvt_pk_bf16_f32 v27, v126, v127
    v_bfe_u32 v13, v1, 2, 2
    v_lshl_add_u32 v13, v4, 2, v13
    v_lshlrev_b32 v7, 10, v13
    v_bfe_u32 v13, v1, 4, 1
    v_lshl_add_u32 v7, v13, 6, v7
    v_and_b32 v13, 3, v1
    v_lshl_add_u32 v7, v13, 4, v7
    s_and_b32 s63, s54, 7
    s_lshl_b32 s63, s63, 7
    s_mul_i32 s60, s59, 458752
    s_lshl_b32 s62, s58, 13
    s_add_u32 s60, s60, s62
    s_add_u32 s60, s60, s63
    v_accvgpr_read_b32 v8, a63
    s_cmp_lt_u32 s53, 2
    s_cbranch_scc1 HZ_3
    v_subrev_u32 v15, 1024, v14
POLL_5:
    buffer_load_dword v13, v15, s[48:51], 0 offen sc1
    s_waitcnt vmcnt(0)
    v_cmp_ne_u32 vcc, s55, v13
    s_cbranch_vccz POLLD_6
    s_cmp_eq_u32 s96, 0
    s_cbranch_scc1 POLLD_6
    s_sub_u32 s96, s96, 1
    s_sleep 1
    s_branch POLL_5
POLLD_6:
    s_sub_u32 s99, s98, 524288
    buffer_load_dwordx4 v[64:67], v2, s[48:51], s99 offen offset:0 sc1
    buffer_load_dwordx4 v[68:71], v2, s[48:51], s99 offen offset:1024 sc1
    s_branch HD_4
HZ_3:
    v_mov_b32 v64, 0
    v_mov_b32 v65, 0
    v_mov_b32 v66, 0
    v_mov_b32 v67, 0
    v_mov_b32 v68, 0
    v_mov_b32 v69, 0
    v_mov_b32 v70, 0
    v_mov_b32 v71, 0
HD_4:
    s_cmp_lt_u32 s53, 1
    s_cbranch_scc1 HZ_7
    v_subrev_u32 v15, 512, v14
POLL_9:
    buffer_load_dword v13, v15, s[48:51], 0 offen sc1
    s_waitcnt vmcnt(0)
    v_cmp_ne_u32 vcc, s55, v13
    s_cbranch_vccz POLLD_10
    s_cmp_eq_u32 s96, 0
    s_cbranch_scc1 POLLD_10
    s_sub_u32 s96, s96, 1
    s_sleep 1
    s_branch POLL_9
POLLD_10:
    s_sub_u32 s99, s98, 262144
    buffer_load_dwordx4 v[72:75], v2, s[48:51], s99 offen offset:0 sc1
    buffer_load_dwordx4 v[76:79], v2, s[48:51], s99 offen offset:1024 sc1
    s_branch HD_8
HZ_7:
    v_mov_b32 v72, 0
    v_mov_b32 v73, 0
    v_mov_b32 v74, 0
    v_mov_b32 v75, 0
    v_mov_b32 v76, 0
    v_mov_b32 v77, 0
    v_mov_b32 v78, 0
    v_mov_b32 v79, 0
HD_8:
    s_cmp_lt_u32 s52, 4
    s_cbranch_scc1 NOG2
    v_lshlrev_b32 v80, 4, v0
    s_mov_b32 s99, 4096
    s_mov_b32 s98, 8192
MG_11:
    buffer_load_dwordx4 v[84:87], v80, s[48:51], s99 offen offset:0 sc1
    buffer_load_dwordx4 v[88:91], v80, s[48:51], s98 offen sc1
    s_waitcnt vmcnt(0)
    v_cmp_ne_u32 vcc, s55, v85
    v_cmp_ne_u32 s[62:63], s55, v87
    s_nop 0
    s_or_b64 vcc, vcc, s[62:63]
    v_cmp_ne_u32 s[62:63], s55, v89
    s_nop 0
    s_or_b64 vcc, vcc, s[62:63]
    v_cmp_ne_u32 s[62:63], s55, v91
    s_nop 0
    s_or_b64 vcc, vcc, s[62:63]
    s_cbranch_vccz MGD_12
    s_cmp_eq_u32 s96, 0
    s_cbranch_scc1 MGD_12
    s_sub_u32 s96, s96, 1
    s_sleep 1
    s_branch MG_11
MGD_12:
    v_lshlrev_b32 v92, 16, v84
    v_and_b32 v93, 0xffff0000, v84
    v_lshlrev_b32 v94, 16, v86
    v_and_b32 v95, 0xffff0000, v86
    v_lshlrev_b32 v96, 16, v88
    v_and_b32 v97, 0xffff0000, v88
    v_lshlrev_b32 v98, 16, v90
    v_and_b32 v99, 0xffff0000, v90
    s_cmp_lt_u32 s52, 6
    s_cselect_b32 s62, 1.0, 0
    v_add_f32 v96, s62, v96
    v_add_f32 v97, s62, v97
    v_add_f32 v98, s62, v98
    v_add_f32 v99, s62, v99
    v_cvt_pk_bf16_f32 v88, v96, v97
    v_cvt_pk_bf16_f32 v89, v98, v99
    v_lshlrev_b32 v96, 16, v88
    v_and_b32 v97, 0xffff0000, v88
    v_lshlrev_b32 v98, 16, v89
    v_and_b32 v99, 0xffff0000, v89
    s_cselect_b64 vcc, -1, 0
    v_cndmask_b32 v88, v84, v88, vcc
    v_cndmask_b32 v89, v86, v89, vcc
    v_lshlrev_b32 v81, 3, v0
    v_add_u32 v81, 157696, v81
    ds_write_b64 v81, v[88:89]
    v_add_u32 v80, 147456, v80
    ds_write_b128 v80, v[92:95]
    ds_write_b128 v80, v[96:99] offset:4096
NOG2:
    s_cmp_ge_u32 s54, 14
    s_cselect_b32 exec_lo, 0, -1
    buffer_load_dword v0, v8, s[48:51], 0 offen sc1
    s_mov_b64 exec, -1
    s_waitcnt vmcnt(1)
    ds_write_b128 v12, v[64:67] offset:0
    ds_write_b128 v12, v[68:71] offset:1024
    ds_write_b128 v12, v[72:75] offset:8192
    ds_write_b128 v12, v[76:79] offset:9216
    v_and_b32 v13, 31, v1
    v_lshlrev_b32 v15, 2, v4
    v_sub_u32 v13, v13, v15
    v_cmp_le_i32 s[64:65], 0, v13
    v_cmp_le_i32 s[66:67], 1, v13
    v_cmp_le_i32 s[68:69], 2, v13
    v_cmp_le_i32 s[70:71], 3, v13
    v_cmp_le_i32 s[72:73], 8, v13
    v_cmp_le_i32 s[74:75], 9, v13
    v_cmp_le_i32 s[76:77], 10, v13
    v_cmp_le_i32 s[78:79], 11, v13
    v_cmp_le_i32 s[80:81], 16, v13
    v_cmp_le_i32 s[82:83], 17, v13
    v_cmp_le_i32 s[84:85], 18, v13
    v_cmp_le_i32 s[86:87], 19, v13
    v_cmp_le_i32 s[88:89], 24, v13
    v_cmp_le_i32 s[90:91], 25, v13
    v_cmp_le_i32 s[92:93], 26, v13
    v_cmp_le_i32 s[94:95], 27, v13
    v_mov_b32 v13, 0xffff
    v_mov_b32 v15, 0xffff0000
    v_cndmask_b32 v16, 0, v13, s[64:65]
    v_cndmask_b32 v9, 0, v15, s[66:67]
    v_or_b32 v16, v16, v9
    v_cndmask_b32 v17, 0, v13, s[68:69]
    v_cndmask_b32 v9, 0, v15, s[70:71]
    v_or_b32 v17, v17, v9
    v_cndmask_b32 v18, 0, v13, s[72:73]
    v_cndmask_b32 v9, 0, v15, s[74:75]
    v_or_b32 v18, v18, v9
    v_cndmask_b32 v19, 0, v13, s[76:77]
    v_cndmask_b32 v9, 0, v15, s[78:79]
    v_or_b32 v19, v19, v9
    v_cndmask_b32 v20, 0, v13, s[80:81]
    v_cndmask_b32 v9, 0, v15, s[82:83]
    v_or_b32 v20, v20, v9
    v_cndmask_b32 v21, 0, v13, s[84:85]
    v_cndmask_b32 v9, 0, v15, s[86:87]
    v_or_b32 v21, v21, v9
    v_cndmask_b32 v22, 0, v13, s[88:89]
    v_cndmask_b32 v9, 0, v15, s[90:91]
    v_or_b32 v22, v22, v9
    v_cndmask_b32 v23, 0, v13, s[92:93]
    v_cndmask_b32 v9, 0, v15, s[94:95]
    v_or_b32 v23, v23, v9
    v_mov_b32 v168, 0x3f803f80
    v_mov_b32 v169, 0x3f803f80
    v_mov_b32 v170, 0x3f803f80
    v_mov_b32 v171, 0x3f803f80
    v_mov_b32 v172, 0x3f803f80
    v_mov_b32 v173, 0x3f803f80
    v_mov_b32 v174, 0x3f803f80
    v_mov_b32 v175, 0x3f803f80
    v_mov_b32 v176, 0x3f803f80
    v_mov_b32 v177, 0x3f803f80
    v_mov_b32 v178, 0x3f803f80
    v_mov_b32 v179, 0x3f803f80
    v_mov_b32 v180, 0x3f803f80
    v_mov_b32 v181, 0x3f803f80
    v_mov_b32 v182, 0x3f803f80
    v_mov_b32 v183, 0x3f803f80
    v_mov_b32 v184, 0x3f803f80
    v_mov_b32 v185, 0x3f803f80
    v_mov_b32 v186, 0x3f803f80
    v_mov_b32 v187, 0x3f803f80
    v_mov_b32 v188, 0x3f803f80
    v_mov_b32 v189, 0x3f803f80
    v_mov_b32 v190, 0x3f803f80
    v_mov_b32 v191, 0x3f803f80
    s_lshl_b32 s62, s53, 2
    s_add_u32 s62, s62, s56
    s_sub_i32 s97, 8, s62
    s_waitcnt lgkmcnt(0)
    s_barrier
    s_cmp_lg_u32 s52, 7
    s_cbranch_scc1 NOATM
    v_mov_b32 v6, 1
    s_mov_b64 exec, 1
    buffer_atomic_add v6, off, s[44:47], 0 sc0 sc1
    s_mov_b64 exec, -1
NOATM:
    v_bfe_u32 v13, v1, 2, 2
    s_movk_i32 s62, 3584
    v_mul_u32_u24 v8, s62, v13
    v_lshrrev_b32 v13, 4, v1
    v_lshl_add_u32 v8, v13, 6, v8
    v_and_b32 v13, 3, v1
    v_lshl_add_u32 v8, v13, 4, v8
    s_lshl_b32 s98, s52, 16
    s_and_b32 s63, s54, 7
    s_lshl_b32 s63, s63, 7
    s_add_u32 s98, s98, s63
    s_mul_i32 s99, s57, 917504
    s_mul_i32 s63, s56, 57344
    s_add_u32 s99, s99, s63
    s_lshl_b32 s63, s54, 8
    s_add_u32 s99, s99, s63
    s_mul_i32 s63, s52, 4096
    s_add_u32 s61, s63, 65536
    s_lshl_b32 s62, s56, 11
    s_lshl_b32 s63, s57, 10
    s_add_u32 s63, s63, s62
    s_add_u32 s63, s63, 98304
    v_add_u32 v9, s63, v2
    v_and_b32 v10, 47, v1
    s_lshl_b32 s63, s57, 8
    s_add_u32 s63, s63, s62
    s_add_u32 s63, s63, 122880
    v_lshl_add_u32 v10, v10, 4, s63
    ds_read_b128 v[28:31], v9 offset:16384
    ds_read_b128 v[32:35], v9 offset:0
    ds_read_b128 v[36:39], v9 offset:14336
    ds_read_b128 v[40:43], v9 offset:12288
    ds_read_b128 v[44:47], v9 offset:10240
    ds_read_b128 v[48:51], v9 offset:8192
    ds_read_b128 v[52:55], v9 offset:6144
    ds_read_b128 v[56:59], v9 offset:4096
    ds_read_b128 v[60:63], v9 offset:2048
    s_mov_b32 s62, 0xffff
    s_mov_b32 s63, 0xffff
    s_mov_b64 exec, s[62:63]
    ds_read_b128 v[168:171], v10 offset:16384
    ds_read_b128 v[172:175], v10 offset:17408
    s_mov_b64 exec, -1
    s_mov_b64 exec, s[62:63]
    ds_read_b128 v[176:179], v10 offset:0
    ds_read_b128 v[180:183], v10 offset:1024
    s_mov_b64 exec, -1
    s_mov_b64 exec, s[62:63]
    ds_read_b128 v[184:187], v10 offset:14336
    ds_read_b128 v[188:191], v10 offset:15360
    s_mov_b64 exec, -1
    s_lshl_b32 s101, s52, 13
    s_add_u32 m0, s101, 0
    s_add_u32 s100, s98, 0
    buffer_load_dwordx4 v7, s[12:15], s100 offen lds
    s_lshl_b32 s101, s52, 13
    s_add_u32 m0, s101, 1024
    s_add_u32 s100, s98, 8192
    buffer_load_dwordx4 v7, s[12:15], s100 offen lds
    s_lshl_b32 s101, s52, 13
    s_add_u32 m0, s101, 2048
    s_add_u32 s100, s98, 16384
    buffer_load_dwordx4 v7, s[12:15], s100 offen lds
    v_mov_b32 v11, 0xf149f2ca
    s_waitcnt lgkmcnt(14)
    v_mfma_f32_32x32x16_bf16 v[64:79], v[28:31], v[24:27], 0
    s_waitcnt lgkmcnt(13)
    v_mfma_f32_32x32x16_bf16 v[80:95], v[32:35], v[24:27], 0
    s_waitcnt lgkmcnt(12)
    v_mfma_f32_32x32x16_bf16 v[96:111], v[36:39], v[24:27], 0
    s_cmp_lt_u32 s53, 2
    s_cbranch_scc1 MGA_13
    s_nop 7
    v_cndmask_b32 v64, v80, v64, s[64:65]
    v_cndmask_b32 v65, v81, v65, s[66:67]
    v_cndmask_b32 v66, v82, v66, s[68:69]
    v_cndmask_b32 v67, v83, v67, s[70:71]
    v_cndmask_b32 v68, v84, v68, s[72:73]
    v_cndmask_b32 v69, v85, v69, s[74:75]
    v_cndmask_b32 v70, v86, v70, s[76:77]
    v_cndmask_b32 v71, v87, v71, s[78:79]
    v_cndmask_b32 v72, v88, v72, s[80:81]
    v_cndmask_b32 v73, v89, v73, s[82:83]
    v_cndmask_b32 v74, v90, v74, s[84:85]
    v_cndmask_b32 v75, v91, v75, s[86:87]
    v_cndmask_b32 v76, v92, v76, s[88:89]
    v_cndmask_b32 v77, v93, v77, s[90:91]
    v_cndmask_b32 v78, v94, v78, s[92:93]
    v_cndmask_b32 v79, v95, v79, s[94:95]
    s_branch MGB_14
MGA_13:
    s_nop 5
    v_cndmask_b32 v64, v11, v64, s[64:65]
    v_cndmask_b32 v65, v11, v65, s[66:67]
    v_cndmask_b32 v66, v11, v66, s[68:69]
    v_cndmask_b32 v67, v11, v67, s[70:71]
    v_cndmask_b32 v68, v11, v68, s[72:73]
    v_cndmask_b32 v69, v11, v69, s[74:75]
    v_cndmask_b32 v70, v11, v70, s[76:77]
    v_cndmask_b32 v71, v11, v71, s[78:79]
    v_cndmask_b32 v72, v11, v72, s[80:81]
    v_cndmask_b32 v73, v11, v73, s[82:83]
    v_cndmask_b32 v74, v11, v74, s[84:85]
    v_cndmask_b32 v75, v11, v75, s[86:87]
    v_cndmask_b32 v76, v11, v76, s[88:89]
    v_cndmask_b32 v77, v11, v77, s[90:91]
    v_cndmask_b32 v78, v11, v78, s[92:93]
    v_cndmask_b32 v79, v11, v79, s[94:95]
MGB_14:
    s_waitcnt lgkmcnt(10)
    v_mfma_f32_32x32x16_bf16 v[80:95], v[44:47], v[24:27], 0
    v_max3_f32 v12, v64, v65, v66
    v_max3_f32 v13, v67, v68, v69
    v_max3_f32 v12, v12, v70, v71
    v_max3_f32 v13, v13, v72, v73
    v_max3_f32 v12, v12, v74, v75
    v_max3_f32 v13, v13, v76, v77
    v_max3_f32 v12, v12, v78, v79
    s_lshl_b32 s101, s52, 13
    s_add_u32 m0, s101, 3072
    s_add_u32 s100, s98, 24576
    buffer_load_dwordx4 v7, s[12:15], s100 offen lds
    s_lshl_b32 s101, s52, 13
    s_add_u32 m0, s101, 4096
    s_add_u32 s100, s98, 32768
    buffer_load_dwordx4 v7, s[12:15], s100 offen lds
    v_mfma_f32_32x32x16_bf16 v[64:79], v[40:43], v[24:27], 0
    s_cmp_gt_i32 s97, 7
    s_cbranch_scc1 P1S2
    v_max3_f32 v12, v12, v96, v97
    v_max3_f32 v13, v13, v98, v99
    v_max3_f32 v12, v12, v100, v101
    v_max3_f32 v13, v13, v102, v103
    v_max3_f32 v12, v12, v104, v105
    v_max3_f32 v13, v13, v106, v107
    v_max3_f32 v12, v12, v108, v109
    v_max3_f32 v13, v13, v110, v111
    s_waitcnt lgkmcnt(9)
    v_mfma_f32_32x32x16_bf16 v[96:111], v[48:51], v[24:27], 0
P1S2:
    s_lshl_b32 s101, s52, 13
    s_add_u32 m0, s101, 5120
    s_add_u32 s100, s98, 40960
    buffer_load_dwordx4 v7, s[12:15], s100 offen lds
    s_cmp_gt_i32 s97, 6
    s_cbranch_scc1 P1S3
    s_nop 3
    v_max3_f32 v12, v12, v64, v65
    v_max3_f32 v13, v13, v66, v67
    v_max3_f32 v12, v12, v68, v69
    v_max3_f32 v13, v13, v70, v71
    v_max3_f32 v12, v12, v72, v73
    v_max3_f32 v13, v13, v74, v75
    v_max3_f32 v12, v12, v76, v77
    v_max3_f32 v13, v13, v78, v79
    s_waitcnt lgkmcnt(8)
    v_mfma_f32_32x32x16_bf16 v[64:79], v[52:55], v[24:27], 0
P1S3:
    s_lshl_b32 s101, s52, 13
    s_add_u32 m0, s101, 6144
    s_add_u32 s100, s98, 49152
    buffer_load_dwordx4 v7, s[12:15], s100 offen lds
    s_cmp_gt_i32 s97, 5
    s_cbranch_scc1 P1S4
    v_max3_f32 v12, v12, v80, v81
    v_max3_f32 v13, v13, v82, v83
    v_max3_f32 v12, v12, v84, v85
    v_max3_f32 v13, v13, v86, v87
    v_max3_f32 v12, v12, v88, v89
    v_max3_f32 v13, v13, v90, v91
    v_max3_f32 v12, v12, v92, v93
    v_max3_f32 v13, v13, v94, v95
    s_waitcnt lgkmcnt(7)
    v_mfma_f32_32x32x16_bf16 v[80:95], v[56:59], v[24:27], 0
P1S4:
    s_lshl_b32 s101, s52, 13
    s_add_u32 m0, s101, 7168
    s_add_u32 s100, s98, 57344
    buffer_load_dwordx4 v7, s[12:15], s100 offen lds
    s_cmp_gt_i32 s97, 4
    s_cbranch_scc1 P1S5
    v_max3_f32 v12, v12, v96, v97
    v_max3_f32 v13, v13, v98, v99
    v_max3_f32 v12, v12, v100, v101
    v_max3_f32 v13, v13, v102, v103
    v_max3_f32 v12, v12, v104, v105
    v_max3_f32 v13, v13, v106, v107
    v_max3_f32 v12, v12, v108, v109
    v_max3_f32 v13, v13, v110, v111
    s_waitcnt lgkmcnt(6)
    v_mfma_f32_32x32x16_bf16 v[96:111], v[60:63], v[24:27], 0
P1S5:
    s_add_u32 m0, s61, 0
    s_add_u32 s100, s99, 0
    buffer_load_dwordx4 v8, s[16:19], s100 offen lds
    s_cmp_gt_i32 s97, 3
    s_cbranch_scc1 P1S6
    v_max3_f32 v12, v12, v64, v65
    v_max3_f32 v13, v13, v66, v67
    v_max3_f32 v12, v12, v68, v69
    v_max3_f32 v13, v13, v70, v71
    v_max3_f32 v12, v12, v72, v73
    v_max3_f32 v13, v13, v74, v75
    v_max3_f32 v12, v12, v76, v77
    v_max3_f32 v13, v13, v78, v79
P1S6:
    s_add_u32 m0, s61, 1024
    s_add_u32 s100, s99, 14336
    buffer_load_dwordx4 v8, s[16:19], s100 offen lds
    s_cmp_gt_i32 s97, 2
    s_cbranch_scc1 P1S7
    v_max3_f32 v12, v12, v80, v81
    v_max3_f32 v13, v13, v82, v83
    v_max3_f32 v12, v12, v84, v85
    v_max3_f32 v13, v13, v86, v87
    v_max3_f32 v12, v12, v88, v89
    v_max3_f32 v13, v13, v90, v91
    v_max3_f32 v12, v12, v92, v93
    v_max3_f32 v13, v13, v94, v95
P1S7:
    s_add_u32 m0, s61, 2048
    s_add_u32 s100, s99, 28672
    buffer_load_dwordx4 v8, s[16:19], s100 offen lds
    s_cmp_gt_i32 s97, 1
    s_cbranch_scc1 P1S8
    v_max3_f32 v12, v12, v96, v97
    v_max3_f32 v13, v13, v98, v99
    v_max3_f32 v12, v12, v100, v101
    v_max3_f32 v13, v13, v102, v103
    v_max3_f32 v12, v12, v104, v105
    v_max3_f32 v13, v13, v106, v107
    v_max3_f32 v12, v12, v108, v109
    v_max3_f32 v13, v13, v110, v111
P1S8:
    s_add_u32 m0, s61, 3072
    s_add_u32 s100, s99, 43008
    buffer_load_dwordx4 v8, s[16:19], s100 offen lds
P1X:
    v_max_f32 v12, v12, v13
    v_mov_b32 v13, v12
    s_nop 1
    v_permlane32_swap_b32 v12, v13
    v_max_f32 v12, v12, v13
    v_sub_f32 v112, 0, v12
    v_sub_f32 v113, 0, v12
    v_sub_f32 v114, 0, v12
    v_sub_f32 v115, 0, v12
    v_sub_f32 v116, 0, v12
    v_sub_f32 v117, 0, v12
    v_sub_f32 v118, 0, v12
    v_sub_f32 v119, 0, v12
    v_sub_f32 v120, 0, v12
    v_sub_f32 v121, 0, v12
    v_sub_f32 v122, 0, v12
    v_sub_f32 v123, 0, v12
    v_sub_f32 v124, 0, v12
    v_sub_f32 v125, 0, v12
    v_sub_f32 v126, 0, v12
    v_sub_f32 v127, 0, v12
    s_waitcnt lgkmcnt(0)
    s_nop 0
    v_mfma_f32_32x32x16_bf16 v[64:79], v[28:31], v[24:27], v[112:127]
    v_mfma_f32_32x32x16_bf16 v[80:95], v[32:35], v[24:27], v[112:127]
    v_mfma_f32_32x32x16_bf16 v[96:111], v[36:39], v[24:27], v[112:127]
    s_cmp_lt_u32 s53, 2
    s_cbranch_scc1 MGA_15
    s_nop 7
    s_nop 0
    v_cndmask_b32 v64, v80, v64, s[64:65]
    v_cndmask_b32 v65, v81, v65, s[66:67]
    v_cndmask_b32 v66, v82, v66, s[68:69]
    v_cndmask_b32 v67, v83, v67, s[70:71]
    v_cndmask_b32 v68, v84, v68, s[72:73]
    v_cndmask_b32 v69, v85, v69, s[74:75]
    v_cndmask_b32 v70, v86, v70, s[76:77]
    v_cndmask_b32 v71, v87, v71, s[78:79]
    v_cndmask_b32 v72, v88, v72, s[80:81]
    v_cndmask_b32 v73, v89, v73, s[82:83]
    v_cndmask_b32 v74, v90, v74, s[84:85]
    v_cndmask_b32 v75, v91, v75, s[86:87]
    v_cndmask_b32 v76, v92, v76, s[88:89]
    v_cndmask_b32 v77, v93, v77, s[90:91]
    v_cndmask_b32 v78, v94, v78, s[92:93]
    v_cndmask_b32 v79, v95, v79, s[94:95]
    s_branch MGB_16
MGA_15:
    s_nop 7
    v_cndmask_b32 v64, v11, v64, s[64:65]
    v_cndmask_b32 v65, v11, v65, s[66:67]
    v_cndmask_b32 v66, v11, v66, s[68:69]
    v_cndmask_b32 v67, v11, v67, s[70:71]
    v_cndmask_b32 v68, v11, v68, s[72:73]
    v_cndmask_b32 v69, v11, v69, s[74:75]
    v_cndmask_b32 v70, v11, v70, s[76:77]
    v_cndmask_b32 v71, v11, v71, s[78:79]
    v_cndmask_b32 v72, v11, v72, s[80:81]
    v_cndmask_b32 v73, v11, v73, s[82:83]
    v_cndmask_b32 v74, v11, v74, s[84:85]
    v_cndmask_b32 v75, v11, v75, s[86:87]
    v_cndmask_b32 v76, v11, v76, s[88:89]
    v_cndmask_b32 v77, v11, v77, s[90:91]
    v_cndmask_b32 v78, v11, v78, s[92:93]
    v_cndmask_b32 v79, v11, v79, s[94:95]
MGB_16:
    v_mfma_f32_32x32x16_bf16 v[80:95], v[44:47], v[24:27], v[112:127]
    s_add_u32 s100, s60, 0
    buffer_load_dwordx4 a[0:3], v7, s[24:27], s100 offen
    s_add_u32 s100, s60, 16384
    buffer_load_dwordx4 a[4:7], v7, s[24:27], s100 offen
    v_exp_f32 v64, v64
    v_exp_f32 v65, v65
    v_exp_f32 v66, v66
    v_exp_f32 v67, v67
    v_exp_f32 v68, v68
    v_exp_f32 v69, v69
    v_exp_f32 v70, v70
    v_exp_f32 v71, v71
    v_cvt_pk_bf16_f32 v144, v64, v65
    v_cvt_pk_bf16_f32 v145, v66, v67
    v_exp_f32 v72, v72
    v_exp_f32 v73, v73
    v_exp_f32 v74, v74
    v_exp_f32 v75, v75
    v_cvt_pk_bf16_f32 v146, v68, v69
    v_cvt_pk_bf16_f32 v147, v70, v71
    v_exp_f32 v76, v76
    v_exp_f32 v77, v77
    v_exp_f32 v78, v78
    v_exp_f32 v79, v79
    v_cvt_pk_bf16_f32 v148, v72, v73
    v_cvt_pk_bf16_f32 v149, v74, v75
    v_cvt_pk_bf16_f32 v150, v76, v77
    v_cvt_pk_bf16_f32 v151, v78, v79
    v_mfma_f32_32x32x16_bf16 v[64:79], v[40:43], v[24:27], v[112:127]
    v_bfi_b32 v160, v16, 0, v144
    v_and_b32 v144, v16, v144
    v_bfi_b32 v161, v17, 0, v145
    v_and_b32 v145, v17, v145
    v_bfi_b32 v162, v18, 0, v146
    v_and_b32 v146, v18, v146
    v_bfi_b32 v163, v19, 0, v147
    v_and_b32 v147, v19, v147
    v_bfi_b32 v164, v20, 0, v148
    v_and_b32 v148, v20, v148
    v_bfi_b32 v165, v21, 0, v149
    v_and_b32 v149, v21, v149
    v_bfi_b32 v166, v22, 0, v150
    v_and_b32 v150, v22, v150
    v_bfi_b32 v167, v23, 0, v151
    v_and_b32 v151, v23, v151
    v_mfma_f32_32x32x16_bf16 v[128:143], v[168:171], v[144:147], 0
    s_nop 0
    v_mfma_f32_32x32x16_bf16 v[128:143], v[172:175], v[148:151], v[128:143]
    s_mov_b64 exec, s[62:63]
    ds_read_b128 v[168:171], v10 offset:12288
    ds_read_b128 v[172:175], v10 offset:13312
    s_mov_b64 exec, -1
    v_mfma_f32_32x32x16_bf16 v[128:143], v[176:179], v[160:163], v[128:143]
    v_mfma_f32_32x32x16_bf16 v[128:143], v[180:183], v[164:167], v[128:143]
    s_mov_b64 exec, s[62:63]
    ds_read_b128 v[176:179], v10 offset:10240
    ds_read_b128 v[180:183], v10 offset:11264
    s_mov_b64 exec, -1
    s_add_u32 s100, s60, 32768
    buffer_load_dwordx4 a[8:11], v7, s[24:27], s100 offen
    s_add_u32 s100, s60, 49152
    buffer_load_dwordx4 a[12:15], v7, s[24:27], s100 offen
    s_cmp_gt_i32 s97, 7
    s_cbranch_scc1 P2S2
    v_exp_f32 v96, v96
    v_exp_f32 v97, v97
    v_exp_f32 v98, v98
    v_exp_f32 v99, v99
    v_exp_f32 v100, v100
    v_exp_f32 v101, v101
    v_exp_f32 v102, v102
    v_exp_f32 v103, v103
    v_cvt_pk_bf16_f32 v152, v96, v97
    v_cvt_pk_bf16_f32 v153, v98, v99
    v_exp_f32 v104, v104
    v_exp_f32 v105, v105
    v_exp_f32 v106, v106
    v_exp_f32 v107, v107
    v_cvt_pk_bf16_f32 v154, v100, v101
    v_cvt_pk_bf16_f32 v155, v102, v103
    v_exp_f32 v108, v108
    v_exp_f32 v109, v109
    v_exp_f32 v110, v110
    v_exp_f32 v111, v111
    v_cvt_pk_bf16_f32 v156, v104, v105
    v_cvt_pk_bf16_f32 v157, v106, v107
    v_cvt_pk_bf16_f32 v158, v108, v109
    v_cvt_pk_bf16_f32 v159, v110, v111
    v_mfma_f32_32x32x16_bf16 v[96:111], v[48:51], v[24:27], v[112:127]
    v_mfma_f32_32x32x16_bf16 v[128:143], v[184:187], v[152:155], v[128:143]
    v_mfma_f32_32x32x16_bf16 v[128:143], v[188:191], v[156:159], v[128:143]
    s_mov_b64 exec, s[62:63]
    ds_read_b128 v[184:187], v10 offset:8192
    ds_read_b128 v[188:191], v10 offset:9216
    s_mov_b64 exec, -1
P2S2:
    s_add_u32 s100, s60, 65536
    buffer_load_dwordx4 a[16:19], v7, s[24:27], s100 offen
    s_add_u32 s100, s60, 81920
    buffer_load_dwordx4 a[20:23], v7, s[24:27], s100 offen
    s_cmp_gt_i32 s97, 6
    s_cbranch_scc1 P2S3
    v_exp_f32 v64, v64
    v_exp_f32 v65, v65
    v_exp_f32 v66, v66
    v_exp_f32 v67, v67
    v_exp_f32 v68, v68
    v_exp_f32 v69, v69
    v_exp_f32 v70, v70
    v_exp_f32 v71, v71
    v_cvt_pk_bf16_f32 v144, v64, v65
    v_cvt_pk_bf16_f32 v145, v66, v67
    v_exp_f32 v72, v72
    v_exp_f32 v73, v73
    v_exp_f32 v74, v74
    v_exp_f32 v75, v75
    v_cvt_pk_bf16_f32 v146, v68, v69
    v_cvt_pk_bf16_f32 v147, v70, v71
    v_exp_f32 v76, v76
    v_exp_f32 v77, v77
    v_exp_f32 v78, v78
    v_exp_f32 v79, v79
    v_cvt_pk_bf16_f32 v148, v72, v73
    v_cvt_pk_bf16_f32 v149, v74, v75
    v_cvt_pk_bf16_f32 v150, v76, v77
    v_cvt_pk_bf16_f32 v151, v78, v79
    v_mfma_f32_32x32x16_bf16 v[64:79], v[52:55], v[24:27], v[112:127]
    s_waitcnt lgkmcnt(4)
    v_mfma_f32_32x32x16_bf16 v[128:143], v[168:171], v[144:147], v[128:143]
    v_mfma_f32_32x32x16_bf16 v[128:143], v[172:175], v[148:151], v[128:143]
    s_mov_b64 exec, s[62:63]
    ds_read_b128 v[168:171], v10 offset:6144
    ds_read_b128 v[172:175], v10 offset:7168
    s_mov_b64 exec, -1
P2S3:
    s_add_u32 s100, s60, 98304
    buffer_load_dwordx4 a[24:27], v7, s[24:27], s100 offen
    s_add_u32 s100, s60, 114688
    buffer_load_dwordx4 a[28:31], v7, s[24:27], s100 offen
    s_cmp_gt_i32 s97, 5
    s_cbranch_scc1 P2S4
    v_exp_f32 v80, v80
    v_exp_f32 v81, v81
    v_exp_f32 v82, v82
    v_exp_f32 v83, v83
    v_exp_f32 v84, v84
    v_exp_f32 v85, v85
    v_exp_f32 v86, v86
    v_exp_f32 v87, v87
    v_cvt_pk_bf16_f32 v152, v80, v81
    v_cvt_pk_bf16_f32 v153, v82, v83
    v_exp_f32 v88, v88
    v_exp_f32 v89, v89
    v_exp_f32 v90, v90
    v_exp_f32 v91, v91
    v_cvt_pk_bf16_f32 v154, v84, v85
    v_cvt_pk_bf16_f32 v155, v86, v87
    v_exp_f32 v92, v92
    v_exp_f32 v93, v93
    v_exp_f32 v94, v94
    v_exp_f32 v95, v95
    v_cvt_pk_bf16_f32 v156, v88, v89
    v_cvt_pk_bf16_f32 v157, v90, v91
    v_cvt_pk_bf16_f32 v158, v92, v93
    v_cvt_pk_bf16_f32 v159, v94, v95
    v_mfma_f32_32x32x16_bf16 v[80:95], v[56:59], v[24:27], v[112:127]
    s_waitcnt lgkmcnt(4)
    v_mfma_f32_32x32x16_bf16 v[128:143], v[176:179], v[152:155], v[128:143]
    v_mfma_f32_32x32x16_bf16 v[128:143], v[180:183], v[156:159], v[128:143]
    s_mov_b64 exec, s[62:63]
    ds_read_b128 v[176:179], v10 offset:4096
    ds_read_b128 v[180:183], v10 offset:5120
    s_mov_b64 exec, -1
P2S4:
    s_add_u32 s100, s60, 294912
    buffer_load_dwordx4 a[32:35], v7, s[24:27], s100 offen
    s_add_u32 s100, s60, 311296
    buffer_load_dwordx4 a[36:39], v7, s[24:27], s100 offen
    s_add_u32 s100, s60, 327680
    buffer_load_dwordx4 a[40:43], v7, s[24:27], s100 offen
    s_cmp_gt_i32 s97, 4
    s_cbranch_scc1 P2S5
    v_exp_f32 v96, v96
    v_exp_f32 v97, v97
    v_exp_f32 v98, v98
    v_exp_f32 v99, v99
    v_exp_f32 v100, v100
    v_exp_f32 v101, v101
    v_exp_f32 v102, v102
    v_exp_f32 v103, v103
    v_cvt_pk_bf16_f32 v144, v96, v97
    v_cvt_pk_bf16_f32 v145, v98, v99
    v_exp_f32 v104, v104
    v_exp_f32 v105, v105
    v_exp_f32 v106, v106
    v_exp_f32 v107, v107
    v_cvt_pk_bf16_f32 v146, v100, v101
    v_cvt_pk_bf16_f32 v147, v102, v103
    v_exp_f32 v108, v108
    v_exp_f32 v109, v109
    v_exp_f32 v110, v110
    v_exp_f32 v111, v111
    v_cvt_pk_bf16_f32 v148, v104, v105
    v_cvt_pk_bf16_f32 v149, v106, v107
    v_cvt_pk_bf16_f32 v150, v108, v109
    v_cvt_pk_bf16_f32 v151, v110, v111
    v_mfma_f32_32x32x16_bf16 v[96:111], v[60:63], v[24:27], v[112:127]
    s_waitcnt lgkmcnt(4)
    v_mfma_f32_32x32x16_bf16 v[128:143], v[184:187], v[144:147], v[128:143]
    v_mfma_f32_32x32x16_bf16 v[128:143], v[188:191], v[148:151], v[128:143]
    s_mov_b64 exec, s[62:63]
    ds_read_b128 v[184:187], v10 offset:2048
    ds_read_b128 v[188:191], v10 offset:3072
    s_mov_b64 exec, -1
P2S5:
    s_add_u32 s100, s60, 344064
    buffer_load_dwordx4 a[44:47], v7, s[24:27], s100 offen
    s_add_u32 s100, s60, 360448
    buffer_load_dwordx4 a[48:51], v7, s[24:27], s100 offen
    s_add_u32 s100, s60, 376832
    buffer_load_dwordx4 a[52:55], v7, s[24:27], s100 offen
    s_cmp_gt_i32 s97, 3
    s_cbranch_scc1 P2S6
    v_exp_f32 v64, v64
    v_exp_f32 v65, v65
    v_exp_f32 v66, v66
    v_exp_f32 v67, v67
    v_exp_f32 v68, v68
    v_exp_f32 v69, v69
    v_exp_f32 v70, v70
    v_exp_f32 v71, v71
    v_cvt_pk_bf16_f32 v152, v64, v65
    v_cvt_pk_bf16_f32 v153, v66, v67
    v_exp_f32 v72, v72
    v_exp_f32 v73, v73
    v_exp_f32 v74, v74
    v_exp_f32 v75, v75
    v_cvt_pk_bf16_f32 v154, v68, v69
    v_cvt_pk_bf16_f32 v155, v70, v71
    v_exp_f32 v76, v76
    v_exp_f32 v77, v77
    v_exp_f32 v78, v78
    v_exp_f32 v79, v79
    v_cvt_pk_bf16_f32 v156, v72, v73
    v_cvt_pk_bf16_f32 v157, v74, v75
    v_cvt_pk_bf16_f32 v158, v76, v77
    v_cvt_pk_bf16_f32 v159, v78, v79
    s_waitcnt lgkmcnt(4)
    v_mfma_f32_32x32x16_bf16 v[128:143], v[168:171], v[152:155], v[128:143]
    v_mfma_f32_32x32x16_bf16 v[128:143], v[172:175], v[156:159], v[128:143]
P2S6:
    s_add_u32 s100, s60, 393216
    buffer_load_dwordx4 a[56:59], v7, s[24:27], s100 offen
    s_add_u32 s100, s60, 409600
    buffer_load_dwordx4 a[60:63], v7, s[24:27], s100 offen
    s_cmp_gt_i32 s97, 2
    s_cbranch_scc1 P2S7
    v_exp_f32 v80, v80
    v_exp_f32 v81, v81
    v_exp_f32 v82, v82
    v_exp_f32 v83, v83
    v_exp_f32 v84, v84
    v_exp_f32 v85, v85
    v_exp_f32 v86, v86
    v_exp_f32 v87, v87
    v_cvt_pk_bf16_f32 v144, v80, v81
    v_cvt_pk_bf16_f32 v145, v82, v83
    v_exp_f32 v88, v88
    v_exp_f32 v89, v89
    v_exp_f32 v90, v90
    v_exp_f32 v91, v91
    v_cvt_pk_bf16_f32 v146, v84, v85
    v_cvt_pk_bf16_f32 v147, v86, v87
    v_exp_f32 v92, v92
    v_exp_f32 v93, v93
    v_exp_f32 v94, v94
    v_exp_f32 v95, v95
    v_cvt_pk_bf16_f32 v148, v88, v89
    v_cvt_pk_bf16_f32 v149, v90, v91
    v_cvt_pk_bf16_f32 v150, v92, v93
    v_cvt_pk_bf16_f32 v151, v94, v95
    s_waitcnt lgkmcnt(2)
    v_mfma_f32_32x32x16_bf16 v[128:143], v[176:179], v[144:147], v[128:143]
    v_mfma_f32_32x32x16_bf16 v[128:143], v[180:183], v[148:151], v[128:143]
P2S7:
    s_cmp_gt_i32 s97, 1
    s_cbranch_scc1 P2S8
    v_exp_f32 v96, v96
    v_exp_f32 v97, v97
    v_exp_f32 v98, v98
    v_exp_f32 v99, v99
    v_exp_f32 v100, v100
    v_exp_f32 v101, v101
    v_exp_f32 v102, v102
    v_exp_f32 v103, v103
    v_cvt_pk_bf16_f32 v152, v96, v97
    v_cvt_pk_bf16_f32 v153, v98, v99
    v_exp_f32 v104, v104
    v_exp_f32 v105, v105
    v_exp_f32 v106, v106
    v_exp_f32 v107, v107
    v_cvt_pk_bf16_f32 v154, v100, v101
    v_cvt_pk_bf16_f32 v155, v102, v103
    v_exp_f32 v108, v108
    v_exp_f32 v109, v109
    v_exp_f32 v110, v110
    v_exp_f32 v111, v111
    v_cvt_pk_bf16_f32 v156, v104, v105
    v_cvt_pk_bf16_f32 v157, v106, v107
    v_cvt_pk_bf16_f32 v158, v108, v109
    v_cvt_pk_bf16_f32 v159, v110, v111
    s_waitcnt lgkmcnt(0)
    v_mfma_f32_32x32x16_bf16 v[128:143], v[184:187], v[152:155], v[128:143]
    v_mfma_f32_32x32x16_bf16 v[128:143], v[188:191], v[156:159], v[128:143]
P2S8:
P2X:
    s_waitcnt lgkmcnt(0)
    s_nop 7
    s_nop 2
    v_rcp_f32 v12, v136
    s_nop 0
    v_mul_f32 v128, v12, v128
    v_mul_f32 v129, v12, v129
    v_mul_f32 v130, v12, v130
    v_mul_f32 v131, v12, v131
    v_mul_f32 v132, v12, v132
    v_mul_f32 v133, v12, v133
    v_mul_f32 v134, v12, v134
    v_mul_f32 v135, v12, v135
    v_cvt_pk_bf16_f32 v136, v128, v129
    v_cvt_pk_bf16_f32 v137, v130, v131
    v_cvt_pk_bf16_f32 v138, v132, v133
    v_cvt_pk_bf16_f32 v139, v134, v135
    s_lshl_b32 s62, s53, 2
    s_add_u32 s62, s62, s56
    s_lshl_b32 s62, s62, 5
    s_lshl_b32 s63, s54, 1
    s_add_u32 s62, s62, s63
    s_add_u32 s62, s62, s57
    s_lshl_b32 s63, s62, 10
    s_add_u32 s63, s63, 5242880
    s_cmp_eq_u32 s3, 1
    s_cbranch_scc1 SF_17
    buffer_store_dwordx4 v[136:139], v2, s[48:51], s63 offen sc1
    s_branch SE_18
SF_17:
    buffer_store_dwordx4 v[136:139], v2, s[48:51], s63 offen
SE_18:
    s_lshl_b32 s62, s62, 2
    s_add_u32 s62, s62, 24576
    v_mov_b32 v14, s62
    s_waitcnt vmcnt(0)
    v_mov_b32 v15, s55
    s_mov_b64 exec, 1
    s_cmp_eq_u32 s3, 1
    s_cbranch_scc1 SF_19
    buffer_store_dword v15, v14, s[48:51], 0 offen sc1
    s_branch SE_20
SF_19:
    buffer_store_dword v15, v14, s[48:51], 0 offen
SE_20:
    s_mov_b64 exec, -1
    s_waitcnt lgkmcnt(0)
    s_barrier
    s_mov_b32 s68, s60
    s_lshr_b32 s62, s54, 3
    s_lshl_b32 s62, s62, 1
    s_add_u32 s62, s62, s58
    s_lshl_b32 s63, s53, 2
    s_add_u32 s64, s62, s63
    s_and_b32 s65, s54, 7
    v_lshrrev_b32 v120, 4, v1
    v_bfe_u32 v121, v1, 3, 1
    v_and_b32 v122, 7, v1
    v_lshlrev_b32 v123, 5, v120
    v_lshl_add_u32 v123, v121, 3, v123
    v_lshl_add_u32 v124, v122, 10, v123
    s_lshl_b32 s62, s64, 15
    s_lshl_b32 s63, s59, 13
    s_add_u32 s62, s62, s63
    s_lshl_b32 s63, s65, 7
    s_add_u32 s66, s62, s63
    s_mov_b32 s69, s63
    s_lshl_b32 s62, s64, 5
    s_lshl_b32 s63, s59, 3
    s_add_u32 s62, s62, s63
    s_lshl_b32 s63, s62, 2
    s_add_u32 s63, s63, 24576
    v_and_b32 v14, 7, v1
    v_lshl_add_u32 v14, v14, 2, s63
    s_lshl_b32 s62, s62, 10
    s_add_u32 s62, s62, 5242880
    s_add_u32 s63, s62, 4096
    s_lshl_b32 s98, s59, 14
    v_lshl_add_u32 v9, v4, 9, v3
    v_add_u32 v9, s98, v9
    ds_read_b64_tr_b16 v[136:137], v9 offset:0
    ds_read_b64_tr_b16 v[138:139], v9 offset:1024
    ds_read_b64_tr_b16 v[140:141], v9 offset:256
    ds_read_b64_tr_b16 v[142:143], v9 offset:1280
    ds_read_b64_tr_b16 v[144:145], v9 offset:2048
    ds_read_b64_tr_b16 v[146:147], v9 offset:3072
    ds_read_b64_tr_b16 v[148:149], v9 offset:2304
    ds_read_b64_tr_b16 v[150:151], v9 offset:3328
    ds_read_b64_tr_b16 v[152:153], v9 offset:4096
    ds_read_b64_tr_b16 v[154:155], v9 offset:5120
    ds_read_b64_tr_b16 v[156:157], v9 offset:4352
    ds_read_b64_tr_b16 v[158:159], v9 offset:5376
POLL_21:
    buffer_load_dword v15, v14, s[48:51], 0 offen sc1
    s_waitcnt vmcnt(0)
    v_cmp_ne_u32 vcc, s55, v15
    s_cbranch_vccz POLLD_22
    s_cmp_eq_u32 s96, 0
    s_cbranch_scc1 POLLD_22
    s_sub_u32 s96, s96, 1
    s_sleep 1
    s_branch POLL_21
POLLD_22:
    buffer_load_dwordx4 v[24:27], v2, s[48:51], s62 offen offset:0 sc1
    buffer_load_dwordx4 v[28:31], v2, s[48:51], s62 offen offset:1024 sc1
    buffer_load_dwordx4 v[32:35], v2, s[48:51], s62 offen offset:2048 sc1
    buffer_load_dwordx4 v[36:39], v2, s[48:51], s62 offen offset:3072 sc1
    buffer_load_dwordx4 v[40:43], v2, s[48:51], s63 offen offset:0 sc1
    buffer_load_dwordx4 v[44:47], v2, s[48:51], s63 offen offset:1024 sc1
    buffer_load_dwordx4 v[48:51], v2, s[48:51], s63 offen offset:2048 sc1
    buffer_load_dwordx4 v[52:55], v2, s[48:51], s63 offen offset:3072 sc1
    buffer_load_dwordx2 v[16:17], v124, s[4:7], s66 offen
    buffer_load_dwordx2 v[18:19], v124, s[4:7], s66 offen offset:16
    s_mul_i32 s62, s57, 917504
    s_mul_i32 s63, s56, 86016
    s_add_u32 s62, s62, s63
    s_lshl_b32 s63, s54, 8
    s_add_u32 s62, s62, s63
    s_add_u32 s62, s62, 229376
    s_mul_i32 s63, s52, 6144
    s_add_u32 m0, s63, 98304
    s_nop 0
    buffer_load_dwordx4 v8, s[16:19], s62 offen lds
    s_add_u32 m0, m0, 1024
    s_add_u32 s62, s62, 14336
    buffer_load_dwordx4 v8, s[16:19], s62 offen lds
    s_add_u32 m0, m0, 1024
    s_add_u32 s62, s62, 14336
    buffer_load_dwordx4 v8, s[16:19], s62 offen lds
    s_add_u32 m0, m0, 1024
    s_add_u32 s62, s62, 14336
    buffer_load_dwordx4 v8, s[16:19], s62 offen lds
    s_add_u32 m0, m0, 1024
    s_add_u32 s62, s62, 14336
    buffer_load_dwordx4 v8, s[16:19], s62 offen lds
    s_add_u32 m0, m0, 1024
    s_add_u32 s62, s62, 14336
    buffer_load_dwordx4 v8, s[16:19], s62 offen lds
    s_add_u32 s62, s68, 425984
    buffer_load_dwordx4 v[184:187], v7, s[24:27], s62 offen
    s_add_u32 s62, s68, 442368
    buffer_load_dwordx4 v[188:191], v7, s[24:27], s62 offen
    buffer_load_dwordx2 v[20:21], v123, s[28:31], s69 offen
    buffer_load_dwordx2 v[22:23], v123, s[28:31], s69 offen offset:16
    s_lshl_b32 s62, s59, 14
    s_lshl_b32 s63, s58, 13
    s_add_u32 s62, s62, s63
    v_add_u32 v10, s62, v2
    s_lshl_b32 s62, s59, 7
    s_add_u32 s62, s62, s63
    v_lshlrev_b32 v13, 9, v121
    v_lshl_add_u32 v13, v122, 4, v13
    v_lshl_add_u32 v11, v120, 11, v13
    v_add_u32 v11, s62, v11
    v_lshl_add_u32 v13, v120, 10, v13
    s_lshl_b32 s62, s65, 8
    s_add_u32 s62, s62, 147456
    v_lshlrev_b32 v12, 6, v120
    v_lshl_add_u32 v12, v121, 4, v12
    v_add_u32 v12, s62, v12
    ds_read_b64_tr_b16 v[160:161], v9 offset:6144
    ds_read_b64_tr_b16 v[162:163], v9 offset:7168
    ds_read_b64_tr_b16 v[164:165], v9 offset:6400
    ds_read_b64_tr_b16 v[166:167], v9 offset:7424
    s_waitcnt vmcnt(19) lgkmcnt(12)
    v_mfma_f32_32x32x16_bf16 v[56:71], v[136:139], v[24:27], 0
    v_mfma_f32_32x32x16_bf16 v[72:87], v[140:143], v[24:27], 0
    ds_read_b64_tr_b16 v[136:137], v9 offset:8192
    ds_read_b64_tr_b16 v[138:139], v9 offset:9216
    ds_read_b64_tr_b16 v[140:141], v9 offset:8448
    ds_read_b64_tr_b16 v[142:143], v9 offset:9472
    s_waitcnt vmcnt(18) lgkmcnt(12)
    v_mfma_f32_32x32x16_bf16 v[56:71], v[144:147], v[28:31], v[56:71]
    v_mfma_f32_32x32x16_bf16 v[72:87], v[148:151], v[28:31], v[72:87]
    ds_read_b64_tr_b16 v[144:145], v9 offset:10240
    ds_read_b64_tr_b16 v[146:147], v9 offset:11264
    ds_read_b64_tr_b16 v[148:149], v9 offset:10496
    ds_read_b64_tr_b16 v[150:151], v9 offset:11520
    s_waitcnt vmcnt(17) lgkmcnt(12)
    v_mfma_f32_32x32x16_bf16 v[56:71], v[152:155], v[32:35], v[56:71]
    v_mfma_f32_32x32x16_bf16 v[72:87], v[156:159], v[32:35], v[72:87]
    ds_read_b64_tr_b16 v[152:153], v9 offset:12288
    ds_read_b64_tr_b16 v[154:155], v9 offset:13312
    ds_read_b64_tr_b16 v[156:157], v9 offset:12544
    ds_read_b64_tr_b16 v[158:159], v9 offset:13568
    s_waitcnt vmcnt(16) lgkmcnt(12)
    v_mfma_f32_32x32x16_bf16 v[56:71], v[160:163], v[36:39], v[56:71]
    v_mfma_f32_32x32x16_bf16 v[72:87], v[164:167], v[36:39], v[72:87]
    ds_read_b64_tr_b16 v[160:161], v9 offset:14336
    ds_read_b64_tr_b16 v[162:163], v9 offset:15360
    ds_read_b64_tr_b16 v[164:165], v9 offset:14592
    ds_read_b64_tr_b16 v[166:167], v9 offset:15616
    s_waitcnt vmcnt(15) lgkmcnt(12)
    v_mfma_f32_32x32x16_bf16 v[56:71], v[136:139], v[40:43], v[56:71]
    v_mfma_f32_32x32x16_bf16 v[72:87], v[140:143], v[40:43], v[72:87]
    s_waitcnt vmcnt(14) lgkmcnt(8)
    v_mfma_f32_32x32x16_bf16 v[56:71], v[144:147], v[44:47], v[56:71]
    v_mfma_f32_32x32x16_bf16 v[72:87], v[148:151], v[44:47], v[72:87]
    s_waitcnt vmcnt(13) lgkmcnt(4)
    v_mfma_f32_32x32x16_bf16 v[56:71], v[152:155], v[48:51], v[56:71]
    v_mfma_f32_32x32x16_bf16 v[72:87], v[156:159], v[48:51], v[72:87]
    s_waitcnt vmcnt(12) lgkmcnt(0)
    v_mfma_f32_32x32x16_bf16 v[56:71], v[160:163], v[52:55], v[56:71]
    v_mfma_f32_32x32x16_bf16 v[72:87], v[164:167], v[52:55], v[72:87]
    ds_read_b128 v[24:27], v12 offset:4096
    ds_read_b128 v[28:31], v12 offset:4128
    ds_read_b128 v[32:35], v12 offset:8192
    ds_read_b128 v[36:39], v12 offset:8224
    s_waitcnt lgkmcnt(0)
    s_barrier
    s_nop 4
    ds_write_b128 v10, v[56:59] offset:0
    ds_write_b128 v10, v[60:63] offset:1024
    ds_write_b128 v10, v[64:67] offset:2048
    ds_write_b128 v10, v[68:71] offset:3072
    ds_write_b128 v10, v[72:75] offset:4096
    ds_write_b128 v10, v[76:79] offset:5120
    ds_write_b128 v10, v[80:83] offset:6144
    ds_write_b128 v10, v[84:87] offset:7168
    s_waitcnt lgkmcnt(0)
    s_barrier
    ds_read_b128 v[88:91], v11 offset:0
    ds_read_b128 v[92:95], v11 offset:1024
    ds_read_b128 v[96:99], v11 offset:16384
    ds_read_b128 v[100:103], v11 offset:17408
    ds_read_b128 v[104:107], v11 offset:32768
    ds_read_b128 v[108:111], v11 offset:33792
    ds_read_b128 v[112:115], v11 offset:49152
    ds_read_b128 v[116:119], v11 offset:50176
    s_waitcnt vmcnt(10)
    v_lshlrev_b32 v128, 16, v16
    v_and_b32 v129, 0xffff0000, v16
    v_lshlrev_b32 v130, 16, v17
    v_and_b32 v131, 0xffff0000, v17
    v_lshlrev_b32 v132, 16, v18
    v_and_b32 v133, 0xffff0000, v18
    v_lshlrev_b32 v134, 16, v19
    v_and_b32 v135, 0xffff0000, v19
    s_lshl_b32 s62, s64, 5
    s_lshl_b32 s63, s65, 2
    s_add_u32 s62, s62, s63
    s_add_u32 s99, s62, s59
    s_lshl_b32 s99, s99, 2
    s_add_u32 s99, s99, 49152
    v_mov_b32 v14, s99
    s_lshl_b32 s99, s62, 6
    s_lshl_b32 s62, s62, 10
    s_lshl_b32 s63, s59, 7
    s_add_u32 s62, s62, s63
    s_add_u32 s62, s62, 7340032
    s_lshl_b32 s63, s59, 6
    s_add_u32 s99, s99, s63
    s_add_u32 s99, s99, 65536
    v_lshlrev_b32 v15, 3, v122
    s_mov_b32 s98, 0x3f803f80
    v_mov_b32 v40, 0
    v_mov_b32 v41, 0
    s_waitcnt lgkmcnt(0)
    s_barrier
    v_add_f32 v88, v88, v96
    v_add_f32 v89, v89, v97
    v_add_f32 v90, v90, v98
    v_add_f32 v91, v91, v99
    v_add_f32 v92, v92, v100
    v_add_f32 v93, v93, v101
    v_add_f32 v94, v94, v102
    v_add_f32 v95, v95, v103
    v_add_f32 v104, v104, v112
    v_add_f32 v105, v105, v113
    v_add_f32 v106, v106, v114
    v_add_f32 v107, v107, v115
    v_add_f32 v108, v108, v116
    v_add_f32 v109, v109, v117
    v_add_f32 v110, v110, v118
    v_add_f32 v111, v111, v119
    v_add_f32 v88, v88, v104
    v_add_f32 v89, v89, v105
    v_add_f32 v90, v90, v106
    v_add_f32 v91, v91, v107
    v_add_f32 v92, v92, v108
    v_add_f32 v93, v93, v109
    v_add_f32 v94, v94, v110
    v_add_f32 v95, v95, v111
    v_fma_f32 v128, v88, v24, v128
    v_fma_f32 v129, v89, v25, v129
    v_fma_f32 v130, v90, v26, v130
    v_fma_f32 v131, v91, v27, v131
    v_fma_f32 v132, v92, v28, v132
    v_fma_f32 v133, v93, v29, v133
    v_fma_f32 v134, v94, v30, v134
    v_fma_f32 v135, v95, v31, v135
    v_cvt_pk_bf16_f32 v16, v128, v129
    v_cvt_pk_bf16_f32 v17, v130, v131
    v_cvt_pk_bf16_f32 v18, v132, v133
    v_cvt_pk_bf16_f32 v19, v134, v135
    v_lshlrev_b32 v128, 16, v16
    v_and_b32 v129, 0xffff0000, v16
    v_lshlrev_b32 v130, 16, v17
    v_and_b32 v131, 0xffff0000, v17
    v_lshlrev_b32 v132, 16, v18
    v_and_b32 v133, 0xffff0000, v18
    v_lshlrev_b32 v134, 16, v19
    v_and_b32 v135, 0xffff0000, v19
    v_mul_f32 v128, v128, v32
    v_mul_f32 v129, v129, v33
    v_mul_f32 v130, v130, v34
    v_mul_f32 v131, v131, v35
    v_mul_f32 v132, v132, v36
    v_mul_f32 v133, v133, v37
    v_mul_f32 v134, v134, v38
    v_mul_f32 v135, v135, v39
    v_cvt_pk_bf16_f32 v44, v128, v129
    v_cvt_pk_bf16_f32 v45, v130, v131
    v_cvt_pk_bf16_f32 v46, v132, v133
    v_cvt_pk_bf16_f32 v47, v134, v135
    s_cmp_eq_u32 s3, 1
    s_cbranch_scc1 SF_23
    buffer_store_dwordx4 v[44:47], v13, s[48:51], s62 offen sc1
    s_branch SE_24
SF_23:
    buffer_store_dwordx4 v[44:47], v13, s[48:51], s62 offen
SE_24:
    v_dot2c_f32_bf16 v40, s98, v16
    v_dot2c_f32_bf16 v41, v16, v16
    v_dot2c_f32_bf16 v40, s98, v17
    v_dot2c_f32_bf16 v41, v17, v17
    v_dot2c_f32_bf16 v40, s98, v18
    v_dot2c_f32_bf16 v41, v18, v18
    v_dot2c_f32_bf16 v40, s98, v19
    v_dot2c_f32_bf16 v41, v19, v19
    s_nop 1
    v_add_f32_dpp v40, v40, v40 row_ror:8 row_mask:0xf bank_mask:0xf
    v_add_f32_dpp v41, v41, v41 row_ror:8 row_mask:0xf bank_mask:0xf
    v_mov_b32 v42, v40
    s_nop 1
    v_permlane16_swap_b32 v42, v40
    v_add_f32 v40, v40, v42
    v_mov_b32 v43, v41
    s_nop 1
    v_permlane16_swap_b32 v43, v41
    v_add_f32 v41, v41, v43
    v_mov_b32 v42, v40
    s_nop 1
    v_permlane32_swap_b32 v42, v40
    v_add_f32 v40, v40, v42
    v_mov_b32 v43, v41
    s_nop 1
    v_permlane32_swap_b32 v43, v41
    v_add_f32 v41, v41, v43
    s_mov_b64 exec, 0xff
    s_cmp_eq_u32 s3, 1
    s_cbranch_scc1 SF_25
    buffer_store_dwordx2 v[40:41], v15, s[48:51], s99 offen sc1
    s_branch SE_26
SF_25:
    buffer_store_dwordx2 v[40:41], v15, s[48:51], s99 offen
SE_26:
    s_mov_b64 exec, -1
    s_waitcnt vmcnt(0)
    v_mov_b32 v15, s55
    s_mov_b64 exec, 1
    s_cmp_eq_u32 s3, 1
    s_cbranch_scc1 SF_27
    buffer_store_dword v15, v14, s[48:51], 0 offen sc1
    s_branch SE_28
SF_27:
    buffer_store_dword v15, v14, s[48:51], 0 offen
SE_28:
    s_mov_b64 exec, -1
    s_mul_i32 s62, s57, 917504
    s_mul_i32 s63, s56, 86016
    s_add_u32 s62, s62, s63
    s_lshl_b32 s63, s54, 8
    s_add_u32 s62, s62, s63
    s_add_u32 s62, s62, 573440
    s_mul_i32 s63, s52, 6144
    s_add_u32 m0, s63, 0
    s_nop 0
    buffer_load_dwordx4 v8, s[16:19], s62 offen lds
    s_add_u32 m0, m0, 1024
    s_add_u32 s62, s62, 14336
    buffer_load_dwordx4 v8, s[16:19], s62 offen lds
    s_add_u32 m0, m0, 1024
    s_add_u32 s62, s62, 14336
    buffer_load_dwordx4 v8, s[16:19], s62 offen lds
    s_add_u32 m0, m0, 1024
    s_add_u32 s62, s62, 14336
    buffer_load_dwordx4 v8, s[16:19], s62 offen lds
    s_add_u32 m0, m0, 1024
    s_add_u32 s62, s62, 14336
    buffer_load_dwordx4 v8, s[16:19], s62 offen lds
    s_add_u32 m0, m0, 1024
    s_add_u32 s62, s62, 14336
    buffer_load_dwordx4 v8, s[16:19], s62 offen lds
    s_cmp_lt_u32 s54, 14
    s_cbranch_scc1 P4
    s_waitcnt vmcnt(0)
    s_barrier
    s_lshl_b32 s63, s52, 10
    s_add_u32 m0, s63, 65536
    s_add_u32 s62, s68, 131072
    buffer_load_dwordx4 v7, s[24:27], s62 offen lds
    s_add_u32 m0, m0, 8192
    s_add_u32 s62, s62, 16384
    buffer_load_dwordx4 v7, s[24:27], s62 offen lds
    s_add_u32 m0, m0, 8192
    s_add_u32 s62, s62, 16384
    buffer_load_dwordx4 v7, s[24:27], s62 offen lds
    s_add_u32 m0, m0, 8192
    s_add_u32 s62, s62, 16384
    buffer_load_dwordx4 v7, s[24:27], s62 offen lds
    s_add_u32 m0, m0, 8192
    s_add_u32 s62, s62, 16384
    buffer_load_dwordx4 v7, s[24:27], s62 offen lds
    s_add_u32 m0, m0, 8192
    s_add_u32 s62, s62, 16384
    buffer_load_dwordx4 v7, s[24:27], s62 offen lds
    s_add_u32 m0, m0, 8192
    s_add_u32 s62, s62, 16384
    buffer_load_dwordx4 v7, s[24:27], s62 offen lds
    s_add_u32 m0, m0, 8192
    s_add_u32 s62, s62, 16384
    buffer_load_dwordx4 v7, s[24:27], s62 offen lds
    s_add_u32 m0, m0, 8192
    s_add_u32 s62, s62, 16384
    buffer_load_dwordx4 v7, s[24:27], s62 offen lds
    s_add_u32 m0, m0, 8192
    s_add_u32 s62, s62, 16384
    buffer_load_dwordx4 v7, s[24:27], s62 offen lds
    s_branch P5
P4:
    s_lshl_b32 s62, s54, 8
    s_lshl_b32 s63, s56, 6
    s_add_u32 s62, s62, s63
    v_and_b32 v13, 31, v1
    v_lshlrev_b32 v15, 1, v13
    buffer_load_ushort v144, v15, s[20:23], s62 offen
    v_lshl_add_u32 v9, v4, 10, v3
    s_mul_i32 s62, s57, 24576
    s_add_u32 s63, s62, 98304
    v_add_u32 v10, s63, v9
    s_add_u32 s63, s62, 0
    v_add_u32 v11, s63, v9
    s_mul_i32 s62, s57, 16384
    s_add_u32 s63, s62, 65536
    v_add_u32 v9, s63, v9
    s_lshl_b32 s63, s56, 8
    v_add_u32 v145, s63, v9
    v_add_u32 v146, s63, v10
    v_add_u32 v147, s63, v11
    v_bfe_u32 v148, v1, 2, 1
    v_lshlrev_b32 v148, 10, v148
    v_lshl_add_u32 v148, v4, 3, v148
    s_lshl_b32 s63, s57, 9
    s_add_u32 s63, s63, 159744
    v_add_u32 v148, s63, v148
    s_lshl_b32 s63, s52, 9
    s_add_u32 s63, s63, 147456
    v_lshl_add_u32 v149, v1, 3, s63
    s_lshl_b32 s62, s53, 2
    s_add_u32 s67, s62, s56
    s_lshl_b32 s62, s67, 7
    s_add_u32 s62, s62, 49152
    v_lshl_add_u32 v14, v13, 2, s62
    s_lshl_b32 s62, s67, 11
    s_add_u32 s62, s62, 65536
    v_lshlrev_b32 v13, 3, v13
    v_lshl_add_u32 v13, v4, 10, v13
    s_lshl_b32 s63, s67, 15
    s_lshl_b32 s98, s57, 14
    s_add_u32 s63, s63, s98
    s_add_u32 s63, s63, 7340032
    s_barrier
    ds_read2_b64 v[104:107], v148 offset0:0 offset1:2
    ds_read_b64_tr_b16 v[108:109], v145 offset:0
    ds_read_b64_tr_b16 v[110:111], v145 offset:2048
    ds_read2_b64 v[112:115], v148 offset0:4 offset1:6
    ds_read_b64_tr_b16 v[116:117], v145 offset:4096
    ds_read_b64_tr_b16 v[118:119], v145 offset:6144
    ds_read2_b64 v[120:123], v148 offset0:8 offset1:10
    ds_read_b64_tr_b16 v[124:125], v145 offset:8192
    ds_read_b64_tr_b16 v[126:127], v145 offset:10240
    ds_read2_b64 v[128:131], v148 offset0:12 offset1:14
    ds_read_b64_tr_b16 v[132:133], v145 offset:12288
    ds_read_b64_tr_b16 v[134:135], v145 offset:14336
    ds_read2_b64 v[152:155], v148 offset0:16 offset1:18
    ds_read_b64_tr_b16 v[156:157], v146 offset:0
    ds_read_b64_tr_b16 v[158:159], v146 offset:2048
    ds_read2_b64 v[160:163], v148 offset0:20 offset1:22
    ds_read_b64_tr_b16 v[164:165], v146 offset:4096
    ds_read_b64_tr_b16 v[166:167], v146 offset:6144
    ds_read2_b64 v[168:171], v148 offset0:24 offset1:26
    ds_read_b64_tr_b16 v[172:173], v146 offset:8192
    ds_read_b64_tr_b16 v[174:175], v146 offset:10240
    s_waitcnt lgkmcnt(15)
    v_mfma_f32_32x32x16_bf16 v[88:103], v[104:107], v[108:111], 0
    ds_read2_b64 v[176:179], v148 offset0:28 offset1:30
    ds_read_b64_tr_b16 v[180:181], v146 offset:12288
    ds_read_b64_tr_b16 v[182:183], v146 offset:14336
    s_waitcnt lgkmcnt(15)
    v_mfma_f32_32x32x16_bf16 v[88:103], v[112:115], v[116:119], v[88:103]
    ds_read2_b64 v[104:107], v148 offset0:32 offset1:34
    ds_read_b64_tr_b16 v[108:109], v146 offset:16384
    ds_read_b64_tr_b16 v[110:111], v146 offset:18432
    s_waitcnt lgkmcnt(15)
    v_mfma_f32_32x32x16_bf16 v[88:103], v[120:123], v[124:127], v[88:103]
    ds_read2_b64 v[112:115], v148 offset0:36 offset1:38
    ds_read_b64_tr_b16 v[116:117], v146 offset:20480
    ds_read_b64_tr_b16 v[118:119], v146 offset:22528
    s_waitcnt lgkmcnt(15)
    v_mfma_f32_32x32x16_bf16 v[88:103], v[128:131], v[132:135], v[88:103]
    s_waitcnt lgkmcnt(15)
    v_mfma_f32_32x32x16_bf16 v[88:103], v[152:155], v[156:159], v[88:103]
    s_waitcnt lgkmcnt(12)
    v_mfma_f32_32x32x16_bf16 v[88:103], v[160:163], v[164:167], v[88:103]
    s_waitcnt lgkmcnt(9)
    v_mfma_f32_32x32x16_bf16 v[88:103], v[168:171], v[172:175], v[88:103]
    s_waitcnt lgkmcnt(6)
    v_mfma_f32_32x32x16_bf16 v[88:103], v[176:179], v[180:183], v[88:103]
    s_waitcnt lgkmcnt(3)
    v_mfma_f32_32x32x16_bf16 v[88:103], v[104:107], v[108:111], v[88:103]
    s_waitcnt lgkmcnt(0)
    v_mfma_f32_32x32x16_bf16 v[88:103], v[112:115], v[116:119], v[88:103]
POLL_29:
    buffer_load_dword v15, v14, s[48:51], 0 offen sc1
    s_waitcnt vmcnt(0)
    v_cmp_ne_u32 vcc, s55, v15
    s_cbranch_vccz POLLD_30
    s_cmp_eq_u32 s96, 0
    s_cbranch_scc1 POLLD_30
    s_sub_u32 s96, s96, 1
    s_sleep 1
    s_branch POLL_29
POLLD_30:
    buffer_load_dwordx2 v[136:137], v13, s[48:51], s62 offen offset:0 sc1
    buffer_load_dwordx2 v[138:139], v13, s[48:51], s62 offen offset:256 sc1
    buffer_load_dwordx2 v[140:141], v13, s[48:51], s62 offen offset:512 sc1
    buffer_load_dwordx2 v[142:143], v13, s[48:51], s62 offen offset:768 sc1
    s_mov_b32 s98, s63
    buffer_load_dwordx4 v[24:27], v2, s[48:51], s98 offen offset:0 sc1
    buffer_load_dwordx4 v[28:31], v2, s[48:51], s98 offen offset:1024 sc1
    buffer_load_dwordx4 v[32:35], v2, s[48:51], s98 offen offset:2048 sc1
    buffer_load_dwordx4 v[36:39], v2, s[48:51], s98 offen offset:3072 sc1
    s_add_u32 s98, s98, 4096
    buffer_load_dwordx4 v[40:43], v2, s[48:51], s98 offen offset:0 sc1
    buffer_load_dwordx4 v[44:47], v2, s[48:51], s98 offen offset:1024 sc1
    s_barrier
    ds_read2_b64 v[120:123], v148 offset0:40 offset1:42
    ds_read_b64_tr_b16 v[124:125], v147 offset:0
    ds_read_b64_tr_b16 v[126:127], v147 offset:2048
    ds_read2_b64 v[128:131], v148 offset0:44 offset1:46
    ds_read_b64_tr_b16 v[132:133], v147 offset:4096
    ds_read_b64_tr_b16 v[134:135], v147 offset:6144
    ds_read2_b64 v[152:155], v148 offset0:48 offset1:50
    ds_read_b64_tr_b16 v[156:157], v147 offset:8192
    ds_read_b64_tr_b16 v[158:159], v147 offset:10240
    ds_read2_b64 v[160:163], v148 offset0:52 offset1:54
    ds_read_b64_tr_b16 v[164:165], v147 offset:12288
    ds_read_b64_tr_b16 v[166:167], v147 offset:14336
    ds_read2_b64 v[168:171], v148 offset0:56 offset1:58
    ds_read_b64_tr_b16 v[172:173], v147 offset:16384
    ds_read_b64_tr_b16 v[174:175], v147 offset:18432
    ds_read2_b64 v[176:179], v148 offset0:60 offset1:62
    ds_read_b64_tr_b16 v[180:181], v147 offset:20480
    ds_read_b64_tr_b16 v[182:183], v147 offset:22528
    s_waitcnt lgkmcnt(15)
    v_mfma_f32_32x32x16_bf16 v[88:103], v[120:123], v[124:127], v[88:103]
    buffer_load_dwordx4 v[48:51], v2, s[48:51], s98 offen offset:2048 sc1
    s_waitcnt lgkmcnt(12)
    v_mfma_f32_32x32x16_bf16 v[88:103], v[128:131], v[132:135], v[88:103]
    buffer_load_dwordx4 v[52:55], v2, s[48:51], s98 offen offset:3072 sc1
    s_waitcnt lgkmcnt(9)
    v_mfma_f32_32x32x16_bf16 v[88:103], v[152:155], v[156:159], v[88:103]
    s_add_u32 s98, s98, 4096
    buffer_load_dwordx4 v[56:59], v2, s[48:51], s98 offen offset:0 sc1
    s_waitcnt lgkmcnt(6)
    v_mfma_f32_32x32x16_bf16 v[88:103], v[160:163], v[164:167], v[88:103]
    buffer_load_dwordx4 v[60:63], v2, s[48:51], s98 offen offset:1024 sc1
    s_waitcnt lgkmcnt(3)
    v_mfma_f32_32x32x16_bf16 v[88:103], v[168:171], v[172:175], v[88:103]
    s_waitcnt lgkmcnt(0)
    v_mfma_f32_32x32x16_bf16 v[88:103], v[176:179], v[180:183], v[88:103]
    ds_read_b64_tr_b16 v[152:153], v9 offset:0
    ds_read_b64_tr_b16 v[154:155], v9 offset:2048
    ds_read_b64_tr_b16 v[156:157], v9 offset:256
    ds_read_b64_tr_b16 v[158:159], v9 offset:2304
    ds_read_b64_tr_b16 v[160:161], v9 offset:512
    ds_read_b64_tr_b16 v[162:163], v9 offset:2560
    ds_read_b64_tr_b16 v[164:165], v9 offset:768
    ds_read_b64_tr_b16 v[166:167], v9 offset:2816
    ds_read_b64_tr_b16 v[168:169], v9 offset:4096
    ds_read_b64_tr_b16 v[170:171], v9 offset:6144
    ds_read_b64_tr_b16 v[172:173], v9 offset:4352
    ds_read_b64_tr_b16 v[174:175], v9 offset:6400
    ds_read_b64_tr_b16 v[176:177], v9 offset:4608
    ds_read_b64_tr_b16 v[178:179], v9 offset:6656
    ds_read_b64_tr_b16 v[180:181], v9 offset:4864
    ds_read_b64_tr_b16 v[182:183], v9 offset:6912
    s_waitcnt vmcnt(10)
    v_add_f32 v136, v136, v138
    v_add_f32 v140, v140, v142
    v_add_f32 v137, v137, v139
    v_add_f32 v141, v141, v143
    v_add_f32 v136, v136, v140
    v_add_f32 v137, v137, v141
    v_mov_b32 v138, v136
    s_nop 1
    v_permlane32_swap_b32 v138, v136
    v_add_f32 v136, v136, v138
    v_mov_b32 v139, v137
    s_nop 1
    v_permlane32_swap_b32 v139, v137
    v_add_f32 v137, v137, v139
    v_mul_f32 v136, 0x3b000000, v136
    v_mul_f32 v137, 0x3b000000, v137
    v_fma_f32 v138, -v136, v136, v137
    v_max_f32 v138, 0, v138
    v_add_f32 v138, 0x3727c5ac, v138
    v_rsq_f32 v8, v138
    s_nop 0
    v_mul_f32_e64 v139, -v136, v8
    v_mul_f32 v138, v138, v8
    v_sub_f32 v136, 0, v136
    s_mov_b32 vcc_lo, 0
    s_mov_b32 vcc_hi, -1
    v_cndmask_b32 v136, v136, v138, vcc
    v_cvt_pk_bf16_f32 v137, v136, v136
    v_and_b32 v137, 0xffff0000, v137
    v_sub_f32 v138, v136, v137
    v_cvt_pk_bf16_f32 v12, v137, v138
    v_mov_b32 v13, v12
    v_mov_b32 v14, 0
    v_mov_b32 v15, 0
    s_cmp_eq_u32 s57, 0
    s_cselect_b32 vcc_hi, -1, 0
    v_lshlrev_b32 v144, 16, v144
    v_cndmask_b32 v144, 0, v144, vcc
    v_add_f32 v144, v144, v88
    v_cvt_pk_bf16_f32 v146, v144, v144
    v_and_b32 v145, 0xffff0000, v146
    v_sub_f32 v145, v144, v145
    v_cvt_pk_bf16_f32 v147, v145, v145
    ds_write_b64 v149, v[146:147]
    s_lshl_b32 s63, s57, 11
    s_add_u32 s63, s63, 147456
    s_waitcnt vmcnt(9) lgkmcnt(9)
    v_mfma_f32_32x32x16_bf16 v[88:103], v[152:155], v[24:27], 0
    v_mfma_f32_32x32x16_bf16 v[104:119], v[156:159], v[24:27], 0
    v_mfma_f32_32x32x16_bf16 v[120:135], v[160:163], v[24:27], 0
    v_mfma_f32_32x32x16_bf16 v[136:151], v[164:167], v[24:27], 0
    ds_read_b64_tr_b16 v[152:153], v9 offset:8192
    ds_read_b64_tr_b16 v[154:155], v9 offset:10240
    ds_read_b64_tr_b16 v[156:157], v9 offset:8448
    ds_read_b64_tr_b16 v[158:159], v9 offset:10496
    ds_read_b64_tr_b16 v[160:161], v9 offset:8704
    ds_read_b64_tr_b16 v[162:163], v9 offset:10752
    ds_read_b64_tr_b16 v[164:165], v9 offset:8960
    ds_read_b64_tr_b16 v[166:167], v9 offset:11008
    buffer_load_dwordx4 v[64:67], v2, s[48:51], s98 offen offset:2048 sc1
    s_waitcnt vmcnt(9) lgkmcnt(9)
    v_mfma_f32_32x32x16_bf16 v[88:103], v[168:171], v[28:31], v[88:103]
    v_mfma_f32_32x32x16_bf16 v[104:119], v[172:175], v[28:31], v[104:119]
    v_mfma_f32_32x32x16_bf16 v[120:135], v[176:179], v[28:31], v[120:135]
    v_mfma_f32_32x32x16_bf16 v[136:151], v[180:183], v[28:31], v[136:151]
    ds_read_b64_tr_b16 v[168:169], v9 offset:12288
    ds_read_b64_tr_b16 v[170:171], v9 offset:14336
    ds_read_b64_tr_b16 v[172:173], v9 offset:12544
    ds_read_b64_tr_b16 v[174:175], v9 offset:14592
    ds_read_b64_tr_b16 v[176:177], v9 offset:12800
    ds_read_b64_tr_b16 v[178:179], v9 offset:14848
    ds_read_b64_tr_b16 v[180:181], v9 offset:13056
    ds_read_b64_tr_b16 v[182:183], v9 offset:15104
    buffer_load_dwordx4 v[68:71], v2, s[48:51], s98 offen offset:3072 sc1
    s_waitcnt vmcnt(9) lgkmcnt(8)
    v_mfma_f32_32x32x16_bf16 v[88:103], v[152:155], v[32:35], v[88:103]
    v_mfma_f32_32x32x16_bf16 v[104:119], v[156:159], v[32:35], v[104:119]
    v_mfma_f32_32x32x16_bf16 v[120:135], v[160:163], v[32:35], v[120:135]
    v_mfma_f32_32x32x16_bf16 v[136:151], v[164:167], v[32:35], v[136:151]
    ds_read_b64_tr_b16 v[152:153], v10 offset:0
    ds_read_b64_tr_b16 v[154:155], v10 offset:2048
    ds_read_b64_tr_b16 v[156:157], v10 offset:256
    ds_read_b64_tr_b16 v[158:159], v10 offset:2304
    ds_read_b64_tr_b16 v[160:161], v10 offset:512
    ds_read_b64_tr_b16 v[162:163], v10 offset:2560
    ds_read_b64_tr_b16 v[164:165], v10 offset:768
    ds_read_b64_tr_b16 v[166:167], v10 offset:2816
    s_add_u32 s98, s98, 4096
    buffer_load_dwordx4 v[72:75], v2, s[48:51], s98 offen offset:0 sc1
    s_waitcnt vmcnt(9) lgkmcnt(8)
    v_mfma_f32_32x32x16_bf16 v[88:103], v[168:171], v[36:39], v[88:103]
    v_mfma_f32_32x32x16_bf16 v[104:119], v[172:175], v[36:39], v[104:119]
    v_mfma_f32_32x32x16_bf16 v[120:135], v[176:179], v[36:39], v[120:135]
    v_mfma_f32_32x32x16_bf16 v[136:151], v[180:183], v[36:39], v[136:151]
    ds_read_b64_tr_b16 v[168:169], v10 offset:4096
    ds_read_b64_tr_b16 v[170:171], v10 offset:6144
    ds_read_b64_tr_b16 v[172:173], v10 offset:4352
    ds_read_b64_tr_b16 v[174:175], v10 offset:6400
    ds_read_b64_tr_b16 v[176:177], v10 offset:4608
    ds_read_b64_tr_b16 v[178:179], v10 offset:6656
    ds_read_b64_tr_b16 v[180:181], v10 offset:4864
    ds_read_b64_tr_b16 v[182:183], v10 offset:6912
    buffer_load_dwordx4 v[76:79], v2, s[48:51], s98 offen offset:1024 sc1
    s_waitcnt vmcnt(9) lgkmcnt(8)
    v_mfma_f32_32x32x16_bf16 v[88:103], v[152:155], v[40:43], v[88:103]
    v_mfma_f32_32x32x16_bf16 v[104:119], v[156:159], v[40:43], v[104:119]
    v_mfma_f32_32x32x16_bf16 v[120:135], v[160:163], v[40:43], v[120:135]
    v_mfma_f32_32x32x16_bf16 v[136:151], v[164:167], v[40:43], v[136:151]
    ds_read_b64_tr_b16 v[152:153], v10 offset:8192
    ds_read_b64_tr_b16 v[154:155], v10 offset:10240
    ds_read_b64_tr_b16 v[156:157], v10 offset:8448
    ds_read_b64_tr_b16 v[158:159], v10 offset:10496
    ds_read_b64_tr_b16 v[160:161], v10 offset:8704
    ds_read_b64_tr_b16 v[162:163], v10 offset:10752
    ds_read_b64_tr_b16 v[164:165], v10 offset:8960
    ds_read_b64_tr_b16 v[166:167], v10 offset:11008
    buffer_load_dwordx4 v[80:83], v2, s[48:51], s98 offen offset:2048 sc1
    s_waitcnt vmcnt(9) lgkmcnt(8)
    v_mfma_f32_32x32x16_bf16 v[88:103], v[168:171], v[44:47], v[88:103]
    v_mfma_f32_32x32x16_bf16 v[104:119], v[172:175], v[44:47], v[104:119]
    v_mfma_f32_32x32x16_bf16 v[120:135], v[176:179], v[44:47], v[120:135]
    v_mfma_f32_32x32x16_bf16 v[136:151], v[180:183], v[44:47], v[136:151]
    ds_read_b64_tr_b16 v[168:169], v10 offset:12288
    ds_read_b64_tr_b16 v[170:171], v10 offset:14336
    ds_read_b64_tr_b16 v[172:173], v10 offset:12544
    ds_read_b64_tr_b16 v[174:175], v10 offset:14592
    ds_read_b64_tr_b16 v[176:177], v10 offset:12800
    ds_read_b64_tr_b16 v[178:179], v10 offset:14848
    ds_read_b64_tr_b16 v[180:181], v10 offset:13056
    ds_read_b64_tr_b16 v[182:183], v10 offset:15104
    buffer_load_dwordx4 v[84:87], v2, s[48:51], s98 offen offset:3072 sc1
    s_waitcnt vmcnt(9) lgkmcnt(8)
    v_mfma_f32_32x32x16_bf16 v[88:103], v[152:155], v[48:51], v[88:103]
    v_mfma_f32_32x32x16_bf16 v[104:119], v[156:159], v[48:51], v[104:119]
    v_mfma_f32_32x32x16_bf16 v[120:135], v[160:163], v[48:51], v[120:135]
    v_mfma_f32_32x32x16_bf16 v[136:151], v[164:167], v[48:51], v[136:151]
    ds_read_b64_tr_b16 v[152:153], v10 offset:16384
    ds_read_b64_tr_b16 v[154:155], v10 offset:18432
    ds_read_b64_tr_b16 v[156:157], v10 offset:16640
    ds_read_b64_tr_b16 v[158:159], v10 offset:18688
    ds_read_b64_tr_b16 v[160:161], v10 offset:16896
    ds_read_b64_tr_b16 v[162:163], v10 offset:18944
    ds_read_b64_tr_b16 v[164:165], v10 offset:17152
    ds_read_b64_tr_b16 v[166:167], v10 offset:19200
    s_waitcnt vmcnt(8) lgkmcnt(8)
    v_mfma_f32_32x32x16_bf16 v[88:103], v[168:171], v[52:55], v[88:103]
    v_mfma_f32_32x32x16_bf16 v[104:119], v[172:175], v[52:55], v[104:119]
    v_mfma_f32_32x32x16_bf16 v[120:135], v[176:179], v[52:55], v[120:135]
    v_mfma_f32_32x32x16_bf16 v[136:151], v[180:183], v[52:55], v[136:151]
    ds_read_b64_tr_b16 v[168:169], v10 offset:20480
    ds_read_b64_tr_b16 v[170:171], v10 offset:22528
    ds_read_b64_tr_b16 v[172:173], v10 offset:20736
    ds_read_b64_tr_b16 v[174:175], v10 offset:22784
    ds_read_b64_tr_b16 v[176:177], v10 offset:20992
    ds_read_b64_tr_b16 v[178:179], v10 offset:23040
    ds_read_b64_tr_b16 v[180:181], v10 offset:21248
    ds_read_b64_tr_b16 v[182:183], v10 offset:23296
    s_waitcnt vmcnt(7) lgkmcnt(8)
    v_mfma_f32_32x32x16_bf16 v[88:103], v[152:155], v[56:59], v[88:103]
    v_mfma_f32_32x32x16_bf16 v[104:119], v[156:159], v[56:59], v[104:119]
    v_mfma_f32_32x32x16_bf16 v[120:135], v[160:163], v[56:59], v[120:135]
    v_mfma_f32_32x32x16_bf16 v[136:151], v[164:167], v[56:59], v[136:151]
    ds_read_b64_tr_b16 v[152:153], v11 offset:0
    ds_read_b64_tr_b16 v[154:155], v11 offset:2048
    ds_read_b64_tr_b16 v[156:157], v11 offset:256
    ds_read_b64_tr_b16 v[158:159], v11 offset:2304
    ds_read_b64_tr_b16 v[160:161], v11 offset:512
    ds_read_b64_tr_b16 v[162:163], v11 offset:2560
    ds_read_b64_tr_b16 v[164:165], v11 offset:768
    ds_read_b64_tr_b16 v[166:167], v11 offset:2816
    s_waitcnt vmcnt(6) lgkmcnt(8)
    v_mfma_f32_32x32x16_bf16 v[88:103], v[168:171], v[60:63], v[88:103]
    v_mfma_f32_32x32x16_bf16 v[104:119], v[172:175], v[60:63], v[104:119]
    v_mfma_f32_32x32x16_bf16 v[120:135], v[176:179], v[60:63], v[120:135]
    v_mfma_f32_32x32x16_bf16 v[136:151], v[180:183], v[60:63], v[136:151]
    ds_read_b64_tr_b16 v[168:169], v11 offset:4096
    ds_read_b64_tr_b16 v[170:171], v11 offset:6144
    ds_read_b64_tr_b16 v[172:173], v11 offset:4352
    ds_read_b64_tr_b16 v[174:175], v11 offset:6400
    ds_read_b64_tr_b16 v[176:177], v11 offset:4608
    ds_read_b64_tr_b16 v[178:179], v11 offset:6656
    ds_read_b64_tr_b16 v[180:181], v11 offset:4864
    ds_read_b64_tr_b16 v[182:183], v11 offset:6912
    s_lshl_b32 s99, s52, 10
    s_add_u32 s99, s99, 65536
    s_barrier
    v_lshl_add_u32 v40, v1, 3, s63
    ds_read_b64 v[24:25], v40 offset:0
    v_mov_b32 v26, 0
    v_mov_b32 v27, 0
    ds_read_b64 v[28:29], v40 offset:512
    v_mov_b32 v30, 0
    v_mov_b32 v31, 0
    ds_read_b64 v[32:33], v40 offset:1024
    v_mov_b32 v34, 0
    v_mov_b32 v35, 0
    ds_read_b64 v[36:37], v40 offset:1536
    v_mov_b32 v38, 0
    v_mov_b32 v39, 0
    s_waitcnt vmcnt(5) lgkmcnt(12)
    v_mfma_f32_32x32x16_bf16 v[88:103], v[152:155], v[64:67], v[88:103]
    v_mfma_f32_32x32x16_bf16 v[104:119], v[156:159], v[64:67], v[104:119]
    v_mfma_f32_32x32x16_bf16 v[120:135], v[160:163], v[64:67], v[120:135]
    v_mfma_f32_32x32x16_bf16 v[136:151], v[164:167], v[64:67], v[136:151]
    ds_read_b64_tr_b16 v[152:153], v11 offset:8192
    ds_read_b64_tr_b16 v[154:155], v11 offset:10240
    ds_read_b64_tr_b16 v[156:157], v11 offset:8448
    ds_read_b64_tr_b16 v[158:159], v11 offset:10496
    ds_read_b64_tr_b16 v[160:161], v11 offset:8704
    ds_read_b64_tr_b16 v[162:163], v11 offset:10752
    ds_read_b64_tr_b16 v[164:165], v11 offset:8960
    ds_read_b64_tr_b16 v[166:167], v11 offset:11008
    s_add_u32 m0, s99, 0
    s_add_u32 s62, s68, 131072
    buffer_load_dwordx4 v7, s[24:27], s62 offen lds
    s_add_u32 m0, s99, 8192
    s_add_u32 s62, s68, 147456
    buffer_load_dwordx4 v7, s[24:27], s62 offen lds
    s_waitcnt vmcnt(6) lgkmcnt(12)
    v_mfma_f32_32x32x16_bf16 v[88:103], v[168:171], v[68:71], v[88:103]
    v_mfma_f32_32x32x16_bf16 v[104:119], v[172:175], v[68:71], v[104:119]
    v_mfma_f32_32x32x16_bf16 v[120:135], v[176:179], v[68:71], v[120:135]
    v_mfma_f32_32x32x16_bf16 v[136:151], v[180:183], v[68:71], v[136:151]
    ds_read_b64_tr_b16 v[168:169], v11 offset:12288
    ds_read_b64_tr_b16 v[170:171], v11 offset:14336
    ds_read_b64_tr_b16 v[172:173], v11 offset:12544
    ds_read_b64_tr_b16 v[174:175], v11 offset:14592
    ds_read_b64_tr_b16 v[176:177], v11 offset:12800
    ds_read_b64_tr_b16 v[178:179], v11 offset:14848
    ds_read_b64_tr_b16 v[180:181], v11 offset:13056
    ds_read_b64_tr_b16 v[182:183], v11 offset:15104
    s_add_u32 m0, s99, 16384
    s_add_u32 s62, s68, 163840
    buffer_load_dwordx4 v7, s[24:27], s62 offen lds
    s_add_u32 m0, s99, 24576
    s_add_u32 s62, s68, 180224
    buffer_load_dwordx4 v7, s[24:27], s62 offen lds
    s_waitcnt vmcnt(7) lgkmcnt(8)
    v_mfma_f32_32x32x16_bf16 v[88:103], v[152:155], v[72:75], v[88:103]
    v_mfma_f32_32x32x16_bf16 v[104:119], v[156:159], v[72:75], v[104:119]
    v_mfma_f32_32x32x16_bf16 v[120:135], v[160:163], v[72:75], v[120:135]
    v_mfma_f32_32x32x16_bf16 v[136:151], v[164:167], v[72:75], v[136:151]
    ds_read_b64_tr_b16 v[152:153], v11 offset:16384
    ds_read_b64_tr_b16 v[154:155], v11 offset:18432
    ds_read_b64_tr_b16 v[156:157], v11 offset:16640
    ds_read_b64_tr_b16 v[158:159], v11 offset:18688
    ds_read_b64_tr_b16 v[160:161], v11 offset:16896
    ds_read_b64_tr_b16 v[162:163], v11 offset:18944
    ds_read_b64_tr_b16 v[164:165], v11 offset:17152
    ds_read_b64_tr_b16 v[166:167], v11 offset:19200
    s_add_u32 m0, s99, 32768
    s_add_u32 s62, s68, 196608
    buffer_load_dwordx4 v7, s[24:27], s62 offen lds
    s_add_u32 m0, s99, 40960
    s_add_u32 s62, s68, 212992
    buffer_load_dwordx4 v7, s[24:27], s62 offen lds
    s_waitcnt vmcnt(8) lgkmcnt(8)
    v_mfma_f32_32x32x16_bf16 v[88:103], v[168:171], v[76:79], v[88:103]
    v_mfma_f32_32x32x16_bf16 v[104:119], v[172:175], v[76:79], v[104:119]
    v_mfma_f32_32x32x16_bf16 v[120:135], v[176:179], v[76:79], v[120:135]
    v_mfma_f32_32x32x16_bf16 v[136:151], v[180:183], v[76:79], v[136:151]
    ds_read_b64_tr_b16 v[168:169], v11 offset:20480
    ds_read_b64_tr_b16 v[170:171], v11 offset:22528
    ds_read_b64_tr_b16 v[172:173], v11 offset:20736
    ds_read_b64_tr_b16 v[174:175], v11 offset:22784
    ds_read_b64_tr_b16 v[176:177], v11 offset:20992
    ds_read_b64_tr_b16 v[178:179], v11 offset:23040
    ds_read_b64_tr_b16 v[180:181], v11 offset:21248
    ds_read_b64_tr_b16 v[182:183], v11 offset:23296
    s_add_u32 m0, s99, 49152
    s_add_u32 s62, s68, 229376
    buffer_load_dwordx4 v7, s[24:27], s62 offen lds
    s_add_u32 m0, s99, 57344
    s_add_u32 s62, s68, 245760
    buffer_load_dwordx4 v7, s[24:27], s62 offen lds
    s_waitcnt vmcnt(9) lgkmcnt(8)
    v_mfma_f32_32x32x16_bf16 v[88:103], v[152:155], v[80:83], v[88:103]
    v_mfma_f32_32x32x16_bf16 v[104:119], v[156:159], v[80:83], v[104:119]
    v_mfma_f32_32x32x16_bf16 v[120:135], v[160:163], v[80:83], v[120:135]
    v_mfma_f32_32x32x16_bf16 v[136:151], v[164:167], v[80:83], v[136:151]
    s_add_u32 m0, s99, 65536
    s_add_u32 s62, s68, 262144
    buffer_load_dwordx4 v7, s[24:27], s62 offen lds
    s_add_u32 m0, s99, 73728
    s_add_u32 s62, s68, 278528
    buffer_load_dwordx4 v7, s[24:27], s62 offen lds
    s_waitcnt vmcnt(10) lgkmcnt(0)
    v_mfma_f32_32x32x16_bf16 v[88:103], v[168:171], v[84:87], v[88:103]
    v_mfma_f32_32x32x16_bf16 v[104:119], v[172:175], v[84:87], v[104:119]
    v_mfma_f32_32x32x16_bf16 v[120:135], v[176:179], v[84:87], v[120:135]
    v_mfma_f32_32x32x16_bf16 v[136:151], v[180:183], v[84:87], v[136:151]
    v_mfma_f32_32x32x16_bf16 v[88:103], v[24:27], v[12:15], v[88:103]
    v_mfma_f32_32x32x16_bf16 v[104:119], v[28:31], v[12:15], v[104:119]
    v_mfma_f32_32x32x16_bf16 v[120:135], v[32:35], v[12:15], v[120:135]
    v_mfma_f32_32x32x16_bf16 v[136:151], v[36:39], v[12:15], v[136:151]
    s_lshl_b32 s62, s52, 13
    v_add_u32 v9, s62, v2
    s_xor_b32 s62, s62, 32768
    v_add_u32 v10, s62, v2
    s_mul_i32 s62, s67, 112
    s_lshl_b32 s63, s54, 3
    s_add_u32 s62, s62, s63
    s_lshl_b32 s63, s57, 2
    s_add_u32 s62, s62, s63
    s_lshl_b32 s62, s62, 10
    s_add_u32 s62, s62, 9437184
    s_waitcnt lgkmcnt(0)
    s_barrier
    s_cmp_eq_u32 s57, 0
    s_cbranch_scc1 FR0
    ds_write_b128 v9, v[88:91] offset:0
    ds_write_b128 v9, v[92:95] offset:1024
    ds_write_b128 v9, v[96:99] offset:2048
    ds_write_b128 v9, v[100:103] offset:3072
    ds_write_b128 v9, v[104:107] offset:4096
    ds_write_b128 v9, v[108:111] offset:5120
    ds_write_b128 v9, v[112:115] offset:6144
    ds_write_b128 v9, v[116:119] offset:7168
    s_waitcnt lgkmcnt(0)
    s_barrier
    ds_read_b128 v[24:27], v10 offset:0
    ds_read_b128 v[28:31], v10 offset:1024
    ds_read_b128 v[32:35], v10 offset:2048
    ds_read_b128 v[36:39], v10 offset:3072
    ds_read_b128 v[40:43], v10 offset:4096
    ds_read_b128 v[44:47], v10 offset:5120
    ds_read_b128 v[48:51], v10 offset:6144
    ds_read_b128 v[52:55], v10 offset:7168
    s_waitcnt lgkmcnt(6)
    v_add_f32 v120, v120, v24
    v_add_f32 v121, v121, v25
    v_add_f32 v122, v122, v26
    v_add_f32 v123, v123, v27
    v_add_f32 v124, v124, v28
    v_add_f32 v125, v125, v29
    v_add_f32 v126, v126, v30
    v_add_f32 v127, v127, v31
    v_max_f32 v120, 0, v120
    v_max_f32 v121, 0, v121
    v_max_f32 v122, 0, v122
    v_max_f32 v123, 0, v123
    v_max_f32 v124, 0, v124
    v_max_f32 v125, 0, v125
    v_max_f32 v126, 0, v126
    v_max_f32 v127, 0, v127
    v_mul_f32 v120, v8, v120
    v_mul_f32 v121, v8, v121
    v_mul_f32 v122, v8, v122
    v_mul_f32 v123, v8, v123
    v_mul_f32 v124, v8, v124
    v_mul_f32 v125, v8, v125
    v_mul_f32 v126, v8, v126
    v_mul_f32 v127, v8, v127
    v_mul_f32 v120, v120, v120
    v_mul_f32 v121, v121, v121
    v_mul_f32 v122, v122, v122
    v_mul_f32 v123, v123, v123
    v_mul_f32 v124, v124, v124
    v_mul_f32 v125, v125, v125
    v_mul_f32 v126, v126, v126
    v_mul_f32 v127, v127, v127
    v_cvt_pk_bf16_f32 v88, v120, v121
    v_cvt_pk_bf16_f32 v89, v122, v123
    v_cvt_pk_bf16_f32 v90, v124, v125
    v_cvt_pk_bf16_f32 v91, v126, v127
    s_cmp_eq_u32 s3, 1
    s_cbranch_scc1 SF_31
    buffer_store_dwordx4 v[88:91], v2, s[48:51], s62 offen offset:0 sc1
    s_branch SE_32
SF_31:
    buffer_store_dwordx4 v[88:91], v2, s[48:51], s62 offen offset:0
SE_32:
    s_waitcnt lgkmcnt(4)
    v_add_f32 v128, v128, v32
    v_add_f32 v129, v129, v33
    v_add_f32 v130, v130, v34
    v_add_f32 v131, v131, v35
    v_add_f32 v132, v132, v36
    v_add_f32 v133, v133, v37
    v_add_f32 v134, v134, v38
    v_add_f32 v135, v135, v39
    v_max_f32 v128, 0, v128
    v_max_f32 v129, 0, v129
    v_max_f32 v130, 0, v130
    v_max_f32 v131, 0, v131
    v_max_f32 v132, 0, v132
    v_max_f32 v133, 0, v133
    v_max_f32 v134, 0, v134
    v_max_f32 v135, 0, v135
    v_mul_f32 v128, v8, v128
    v_mul_f32 v129, v8, v129
    v_mul_f32 v130, v8, v130
    v_mul_f32 v131, v8, v131
    v_mul_f32 v132, v8, v132
    v_mul_f32 v133, v8, v133
    v_mul_f32 v134, v8, v134
    v_mul_f32 v135, v8, v135
    v_mul_f32 v128, v128, v128
    v_mul_f32 v129, v129, v129
    v_mul_f32 v130, v130, v130
    v_mul_f32 v131, v131, v131
    v_mul_f32 v132, v132, v132
    v_mul_f32 v133, v133, v133
    v_mul_f32 v134, v134, v134
    v_mul_f32 v135, v135, v135
    v_cvt_pk_bf16_f32 v92, v128, v129
    v_cvt_pk_bf16_f32 v93, v130, v131
    v_cvt_pk_bf16_f32 v94, v132, v133
    v_cvt_pk_bf16_f32 v95, v134, v135
    s_cmp_eq_u32 s3, 1
    s_cbranch_scc1 SF_33
    buffer_store_dwordx4 v[92:95], v2, s[48:51], s62 offen offset:1024 sc1
    s_branch SE_34
SF_33:
    buffer_store_dwordx4 v[92:95], v2, s[48:51], s62 offen offset:1024
SE_34:
    s_waitcnt lgkmcnt(2)
    v_add_f32 v136, v136, v40
    v_add_f32 v137, v137, v41
    v_add_f32 v138, v138, v42
    v_add_f32 v139, v139, v43
    v_add_f32 v140, v140, v44
    v_add_f32 v141, v141, v45
    v_add_f32 v142, v142, v46
    v_add_f32 v143, v143, v47
    v_max_f32 v136, 0, v136
    v_max_f32 v137, 0, v137
    v_max_f32 v138, 0, v138
    v_max_f32 v139, 0, v139
    v_max_f32 v140, 0, v140
    v_max_f32 v141, 0, v141
    v_max_f32 v142, 0, v142
    v_max_f32 v143, 0, v143
    v_mul_f32 v136, v8, v136
    v_mul_f32 v137, v8, v137
    v_mul_f32 v138, v8, v138
    v_mul_f32 v139, v8, v139
    v_mul_f32 v140, v8, v140
    v_mul_f32 v141, v8, v141
    v_mul_f32 v142, v8, v142
    v_mul_f32 v143, v8, v143
    v_mul_f32 v136, v136, v136
    v_mul_f32 v137, v137, v137
    v_mul_f32 v138, v138, v138
    v_mul_f32 v139, v139, v139
    v_mul_f32 v140, v140, v140
    v_mul_f32 v141, v141, v141
    v_mul_f32 v142, v142, v142
    v_mul_f32 v143, v143, v143
    v_cvt_pk_bf16_f32 v96, v136, v137
    v_cvt_pk_bf16_f32 v97, v138, v139
    v_cvt_pk_bf16_f32 v98, v140, v141
    v_cvt_pk_bf16_f32 v99, v142, v143
    s_cmp_eq_u32 s3, 1
    s_cbranch_scc1 SF_35
    buffer_store_dwordx4 v[96:99], v2, s[48:51], s62 offen offset:2048 sc1
    s_branch SE_36
SF_35:
    buffer_store_dwordx4 v[96:99], v2, s[48:51], s62 offen offset:2048
SE_36:
    s_waitcnt lgkmcnt(0)
    v_add_f32 v144, v144, v48
    v_add_f32 v145, v145, v49
    v_add_f32 v146, v146, v50
    v_add_f32 v147, v147, v51
    v_add_f32 v148, v148, v52
    v_add_f32 v149, v149, v53
    v_add_f32 v150, v150, v54
    v_add_f32 v151, v151, v55
    v_max_f32 v144, 0, v144
    v_max_f32 v145, 0, v145
    v_max_f32 v146, 0, v146
    v_max_f32 v147, 0, v147
    v_max_f32 v148, 0, v148
    v_max_f32 v149, 0, v149
    v_max_f32 v150, 0, v150
    v_max_f32 v151, 0, v151
    v_mul_f32 v144, v8, v144
    v_mul_f32 v145, v8, v145
    v_mul_f32 v146, v8, v146
    v_mul_f32 v147, v8, v147
    v_mul_f32 v148, v8, v148
    v_mul_f32 v149, v8, v149
    v_mul_f32 v150, v8, v150
    v_mul_f32 v151, v8, v151
    v_mul_f32 v144, v144, v144
    v_mul_f32 v145, v145, v145
    v_mul_f32 v146, v146, v146
    v_mul_f32 v147, v147, v147
    v_mul_f32 v148, v148, v148
    v_mul_f32 v149, v149, v149
    v_mul_f32 v150, v150, v150
    v_mul_f32 v151, v151, v151
    v_cvt_pk_bf16_f32 v100, v144, v145
    v_cvt_pk_bf16_f32 v101, v146, v147
    v_cvt_pk_bf16_f32 v102, v148, v149
    v_cvt_pk_bf16_f32 v103, v150, v151
    s_cmp_eq_u32 s3, 1
    s_cbranch_scc1 SF_37
    buffer_store_dwordx4 v[100:103], v2, s[48:51], s62 offen offset:3072 sc1
    s_branch SE_38
SF_37:
    buffer_store_dwordx4 v[100:103], v2, s[48:51], s62 offen offset:3072
SE_38:
    s_branch FR1
FR0:
    ds_write_b128 v9, v[120:123] offset:0
    ds_write_b128 v9, v[124:127] offset:1024
    ds_write_b128 v9, v[128:131] offset:2048
    ds_write_b128 v9, v[132:135] offset:3072
    ds_write_b128 v9, v[136:139] offset:4096
    ds_write_b128 v9, v[140:143] offset:5120
    ds_write_b128 v9, v[144:147] offset:6144
    ds_write_b128 v9, v[148:151] offset:7168
    s_waitcnt lgkmcnt(0)
    s_barrier
    ds_read_b128 v[24:27], v10 offset:0
    ds_read_b128 v[28:31], v10 offset:1024
    ds_read_b128 v[32:35], v10 offset:2048
    ds_read_b128 v[36:39], v10 offset:3072
    ds_read_b128 v[40:43], v10 offset:4096
    ds_read_b128 v[44:47], v10 offset:5120
    ds_read_b128 v[48:51], v10 offset:6144
    ds_read_b128 v[52:55], v10 offset:7168
    s_waitcnt lgkmcnt(6)
    v_add_f32 v88, v88, v24
    v_add_f32 v89, v89, v25
    v_add_f32 v90, v90, v26
    v_add_f32 v91, v91, v27
    v_add_f32 v92, v92, v28
    v_add_f32 v93, v93, v29
    v_add_f32 v94, v94, v30
    v_add_f32 v95, v95, v31
    v_max_f32 v88, 0, v88
    v_max_f32 v89, 0, v89
    v_max_f32 v90, 0, v90
    v_max_f32 v91, 0, v91
    v_max_f32 v92, 0, v92
    v_max_f32 v93, 0, v93
    v_max_f32 v94, 0, v94
    v_max_f32 v95, 0, v95
    v_mul_f32 v88, v8, v88
    v_mul_f32 v89, v8, v89
    v_mul_f32 v90, v8, v90
    v_mul_f32 v91, v8, v91
    v_mul_f32 v92, v8, v92
    v_mul_f32 v93, v8, v93
    v_mul_f32 v94, v8, v94
    v_mul_f32 v95, v8, v95
    v_mul_f32 v88, v88, v88
    v_mul_f32 v89, v89, v89
    v_mul_f32 v90, v90, v90
    v_mul_f32 v91, v91, v91
    v_mul_f32 v92, v92, v92
    v_mul_f32 v93, v93, v93
    v_mul_f32 v94, v94, v94
    v_mul_f32 v95, v95, v95
    v_cvt_pk_bf16_f32 v120, v88, v89
    v_cvt_pk_bf16_f32 v121, v90, v91
    v_cvt_pk_bf16_f32 v122, v92, v93
    v_cvt_pk_bf16_f32 v123, v94, v95
    s_cmp_eq_u32 s3, 1
    s_cbranch_scc1 SF_39
    buffer_store_dwordx4 v[120:123], v2, s[48:51], s62 offen offset:0 sc1
    s_branch SE_40
SF_39:
    buffer_store_dwordx4 v[120:123], v2, s[48:51], s62 offen offset:0
SE_40:
    s_waitcnt lgkmcnt(4)
    v_add_f32 v96, v96, v32
    v_add_f32 v97, v97, v33
    v_add_f32 v98, v98, v34
    v_add_f32 v99, v99, v35
    v_add_f32 v100, v100, v36
    v_add_f32 v101, v101, v37
    v_add_f32 v102, v102, v38
    v_add_f32 v103, v103, v39
    v_max_f32 v96, 0, v96
    v_max_f32 v97, 0, v97
    v_max_f32 v98, 0, v98
    v_max_f32 v99, 0, v99
    v_max_f32 v100, 0, v100
    v_max_f32 v101, 0, v101
    v_max_f32 v102, 0, v102
    v_max_f32 v103, 0, v103
    v_mul_f32 v96, v8, v96
    v_mul_f32 v97, v8, v97
    v_mul_f32 v98, v8, v98
    v_mul_f32 v99, v8, v99
    v_mul_f32 v100, v8, v100
    v_mul_f32 v101, v8, v101
    v_mul_f32 v102, v8, v102
    v_mul_f32 v103, v8, v103
    v_mul_f32 v96, v96, v96
    v_mul_f32 v97, v97, v97
    v_mul_f32 v98, v98, v98
    v_mul_f32 v99, v99, v99
    v_mul_f32 v100, v100, v100
    v_mul_f32 v101, v101, v101
    v_mul_f32 v102, v102, v102
    v_mul_f32 v103, v103, v103
    v_cvt_pk_bf16_f32 v124, v96, v97
    v_cvt_pk_bf16_f32 v125, v98, v99
    v_cvt_pk_bf16_f32 v126, v100, v101
    v_cvt_pk_bf16_f32 v127, v102, v103
    s_cmp_eq_u32 s3, 1
    s_cbranch_scc1 SF_41
    buffer_store_dwordx4 v[124:127], v2, s[48:51], s62 offen offset:1024 sc1
    s_branch SE_42
SF_41:
    buffer_store_dwordx4 v[124:127], v2, s[48:51], s62 offen offset:1024
SE_42:
    s_waitcnt lgkmcnt(2)
    v_add_f32 v104, v104, v40
    v_add_f32 v105, v105, v41
    v_add_f32 v106, v106, v42
    v_add_f32 v107, v107, v43
    v_add_f32 v108, v108, v44
    v_add_f32 v109, v109, v45
    v_add_f32 v110, v110, v46
    v_add_f32 v111, v111, v47
    v_max_f32 v104, 0, v104
    v_max_f32 v105, 0, v105
    v_max_f32 v106, 0, v106
    v_max_f32 v107, 0, v107
    v_max_f32 v108, 0, v108
    v_max_f32 v109, 0, v109
    v_max_f32 v110, 0, v110
    v_max_f32 v111, 0, v111
    v_mul_f32 v104, v8, v104
    v_mul_f32 v105, v8, v105
    v_mul_f32 v106, v8, v106
    v_mul_f32 v107, v8, v107
    v_mul_f32 v108, v8, v108
    v_mul_f32 v109, v8, v109
    v_mul_f32 v110, v8, v110
    v_mul_f32 v111, v8, v111
    v_mul_f32 v104, v104, v104
    v_mul_f32 v105, v105, v105
    v_mul_f32 v106, v106, v106
    v_mul_f32 v107, v107, v107
    v_mul_f32 v108, v108, v108
    v_mul_f32 v109, v109, v109
    v_mul_f32 v110, v110, v110
    v_mul_f32 v111, v111, v111
    v_cvt_pk_bf16_f32 v128, v104, v105
    v_cvt_pk_bf16_f32 v129, v106, v107
    v_cvt_pk_bf16_f32 v130, v108, v109
    v_cvt_pk_bf16_f32 v131, v110, v111
    s_cmp_eq_u32 s3, 1
    s_cbranch_scc1 SF_43
    buffer_store_dwordx4 v[128:131], v2, s[48:51], s62 offen offset:2048 sc1
    s_branch SE_44
SF_43:
    buffer_store_dwordx4 v[128:131], v2, s[48:51], s62 offen offset:2048
SE_44:
    s_waitcnt lgkmcnt(0)
    v_add_f32 v112, v112, v48
    v_add_f32 v113, v113, v49
    v_add_f32 v114, v114, v50
    v_add_f32 v115, v115, v51
    v_add_f32 v116, v116, v52
    v_add_f32 v117, v117, v53
    v_add_f32 v118, v118, v54
    v_add_f32 v119, v119, v55
    v_max_f32 v112, 0, v112
    v_max_f32 v113, 0, v113
    v_max_f32 v114, 0, v114
    v_max_f32 v115, 0, v115
    v_max_f32 v116, 0, v116
    v_max_f32 v117, 0, v117
    v_max_f32 v118, 0, v118
    v_max_f32 v119, 0, v119
    v_mul_f32 v112, v8, v112
    v_mul_f32 v113, v8, v113
    v_mul_f32 v114, v8, v114
    v_mul_f32 v115, v8, v115
    v_mul_f32 v116, v8, v116
    v_mul_f32 v117, v8, v117
    v_mul_f32 v118, v8, v118
    v_mul_f32 v119, v8, v119
    v_mul_f32 v112, v112, v112
    v_mul_f32 v113, v113, v113
    v_mul_f32 v114, v114, v114
    v_mul_f32 v115, v115, v115
    v_mul_f32 v116, v116, v116
    v_mul_f32 v117, v117, v117
    v_mul_f32 v118, v118, v118
    v_mul_f32 v119, v119, v119
    v_cvt_pk_bf16_f32 v132, v112, v113
    v_cvt_pk_bf16_f32 v133, v114, v115
    v_cvt_pk_bf16_f32 v134, v116, v117
    v_cvt_pk_bf16_f32 v135, v118, v119
    s_cmp_eq_u32 s3, 1
    s_cbranch_scc1 SF_45
    buffer_store_dwordx4 v[132:135], v2, s[48:51], s62 offen offset:3072 sc1
    s_branch SE_46
SF_45:
    buffer_store_dwordx4 v[132:135], v2, s[48:51], s62 offen offset:3072
SE_46:
FR1:
    s_lshl_b32 s62, s67, 7
    s_lshl_b32 s63, s54, 3
    s_add_u32 s62, s62, s63
    s_lshl_b32 s63, s57, 2
    s_add_u32 s62, s62, s63
    s_add_u32 s62, s62, 36864
    v_mov_b32 v14, s62
    s_barrier
    s_waitcnt vmcnt(0)
    v_mov_b32 v15, s55
    s_mov_b64 exec, 1
    s_cmp_eq_u32 s3, 1
    s_cbranch_scc1 SF_47
    buffer_store_dword v15, v14, s[48:51], 0 offen sc1
    s_branch SE_48
SF_47:
    buffer_store_dword v15, v14, s[48:51], 0 offen
SE_48:
    s_mov_b64 exec, -1
P5:
    s_lshl_b32 s63, s52, 10
    v_add_u32 v168, s63, v2
    v_add_u32 v169, 0x10000, v168
    ds_write_b128 v168, a[0:3] offset:0
    ds_write_b128 v168, a[4:7] offset:8192
    ds_write_b128 v168, a[8:11] offset:16384
    ds_write_b128 v168, a[12:15] offset:24576
    ds_write_b128 v168, a[16:19] offset:32768
    ds_write_b128 v168, a[20:23] offset:40960
    ds_write_b128 v168, a[24:27] offset:49152
    ds_write_b128 v168, a[28:31] offset:57344
    s_lshl_b32 s63, s59, 11
    v_lshl_add_u32 v9, v4, 9, v3
    v_add_u32 v9, s63, v9
    v_add_u32 v170, 0x10000, v9
    v_add_u32 v171, 0x20000, v9
    s_lshl_b32 s62, s64, 7
    s_mul_i32 s63, s59, 28
    s_add_u32 s62, s62, s63
    s_add_u32 s62, s62, 36864
    v_min_u32 v14, 6, v1
    v_lshl_add_u32 v14, v14, 2, s62
    s_mul_i32 s98, s64, 112
    s_add_u32 s98, s98, s63
    s_lshl_b32 s98, s98, 10
    s_add_u32 s98, s98, 9437184
    v_lshrrev_b32 v172, 4, v1
    v_bfe_u32 v173, v1, 3, 1
    v_and_b32 v174, 7, v1
    s_lshl_b32 s62, s59, 14
    s_lshl_b32 s63, s58, 13
    s_add_u32 s62, s62, s63
    v_add_u32 v10, s62, v2
    s_lshl_b32 s62, s59, 7
    s_add_u32 s62, s62, s63
    v_lshlrev_b32 v13, 9, v173
    v_lshl_add_u32 v13, v174, 4, v13
    v_lshl_add_u32 v11, v172, 11, v13
    v_add_u32 v11, s62, v11
    v_lshl_add_u32 v13, v172, 10, v13
    s_lshl_b32 s62, s65, 8
    s_add_u32 s62, s62, 147456
    v_lshlrev_b32 v12, 6, v172
    v_lshl_add_u32 v12, v173, 4, v12
    v_add_u32 v12, s62, v12
    v_lshlrev_b32 v13, 5, v172
    v_lshl_add_u32 v13, v173, 4, v13
    v_lshl_add_u32 v13, v174, 10, v13
    s_waitcnt vmcnt(0) lgkmcnt(0)
    s_barrier
    ds_read_b64_tr_b16 a[0:1], v9 offset:0
    ds_read_b64_tr_b16 a[2:3], v9 offset:1024
    ds_read_b64_tr_b16 a[4:5], v9 offset:256
    ds_read_b64_tr_b16 a[6:7], v9 offset:1280
    ds_read_b64_tr_b16 a[8:9], v9 offset:8192
    ds_read_b64_tr_b16 a[10:11], v9 offset:9216
    ds_read_b64_tr_b16 a[12:13], v9 offset:8448
    ds_read_b64_tr_b16 a[14:15], v9 offset:9472
POLL_49:
    buffer_load_dword v15, v14, s[48:51], 0 offen sc1
    s_waitcnt vmcnt(0)
    v_cmp_ne_u32 vcc, s55, v15
    s_cbranch_vccz POLLD_50
    s_cmp_eq_u32 s96, 0
    s_cbranch_scc1 POLLD_50
    s_sub_u32 s96, s96, 1
    s_sleep 1
    s_branch POLL_49
POLLD_50:
    buffer_load_dwordx4 v[24:27], v2, s[48:51], s98 offen offset:0 sc1
    buffer_load_dwordx4 v[28:31], v2, s[48:51], s98 offen offset:1024 sc1
    buffer_load_dwordx4 v[32:35], v2, s[48:51], s98 offen offset:2048 sc1
    buffer_load_dwordx4 v[36:39], v2, s[48:51], s98 offen offset:3072 sc1
    s_add_u32 s98, s98, 4096
    buffer_load_dwordx4 v[40:43], v2, s[48:51], s98 offen offset:0 sc1
    buffer_load_dwordx4 v[44:47], v2, s[48:51], s98 offen offset:1024 sc1
    buffer_load_dwordx4 v[48:51], v2, s[48:51], s98 offen offset:2048 sc1
    buffer_load_dwordx4 v[52:55], v2, s[48:51], s98 offen offset:3072 sc1
    ds_read_b64_tr_b16 a[16:17], v9 offset:16384
    ds_read_b64_tr_b16 a[18:19], v9 offset:17408
    ds_read_b64_tr_b16 a[20:21], v9 offset:16640
    ds_read_b64_tr_b16 a[22:23], v9 offset:17664
    s_waitcnt vmcnt(7) lgkmcnt(8)
    s_waitcnt lgkmcnt(0)
    v_mfma_f32_32x32x16_bf16 v[136:151], a[0:3], v[24:27], 0
    v_mfma_f32_32x32x16_bf16 v[152:167], a[4:7], v[24:27], 0
    s_add_u32 s98, s98, 4096
    buffer_load_dwordx4 v[56:59], v2, s[48:51], s98 offen offset:0 sc1
    ds_read_b64_tr_b16 a[0:1], v9 offset:24576
    ds_read_b64_tr_b16 a[2:3], v9 offset:25600
    ds_read_b64_tr_b16 a[4:5], v9 offset:24832
    ds_read_b64_tr_b16 a[6:7], v9 offset:25856
    s_waitcnt vmcnt(7)
    v_mfma_f32_32x32x16_bf16 v[136:151], a[8:11], v[28:31], v[136:151]
    v_mfma_f32_32x32x16_bf16 v[152:167], a[12:15], v[28:31], v[152:167]
    buffer_load_dwordx4 v[60:63], v2, s[48:51], s98 offen offset:1024 sc1
    ds_read_b64_tr_b16 a[8:9], v9 offset:32768
    ds_read_b64_tr_b16 a[10:11], v9 offset:33792
    ds_read_b64_tr_b16 a[12:13], v9 offset:33024
    ds_read_b64_tr_b16 a[14:15], v9 offset:34048
    s_waitcnt vmcnt(7)
    v_mfma_f32_32x32x16_bf16 v[136:151], a[16:19], v[32:35], v[136:151]
    v_mfma_f32_32x32x16_bf16 v[152:167], a[20:23], v[32:35], v[152:167]
    buffer_load_dwordx4 v[64:67], v2, s[48:51], s98 offen offset:2048 sc1
    ds_read_b64_tr_b16 a[16:17], v9 offset:40960
    ds_read_b64_tr_b16 a[18:19], v9 offset:41984
    ds_read_b64_tr_b16 a[20:21], v9 offset:41216
    ds_read_b64_tr_b16 a[22:23], v9 offset:42240
    s_waitcnt vmcnt(7) lgkmcnt(8)
    v_mfma_f32_32x32x16_bf16 v[136:151], a[0:3], v[36:39], v[136:151]
    v_mfma_f32_32x32x16_bf16 v[152:167], a[4:7], v[36:39], v[152:167]
    buffer_load_dwordx4 v[68:71], v2, s[48:51], s98 offen offset:3072 sc1
    ds_read_b64_tr_b16 a[0:1], v9 offset:49152
    ds_read_b64_tr_b16 a[2:3], v9 offset:50176
    ds_read_b64_tr_b16 a[4:5], v9 offset:49408
    ds_read_b64_tr_b16 a[6:7], v9 offset:50432
    s_waitcnt vmcnt(7) lgkmcnt(8)
    v_mfma_f32_32x32x16_bf16 v[136:151], a[8:11], v[40:43], v[136:151]
    v_mfma_f32_32x32x16_bf16 v[152:167], a[12:15], v[40:43], v[152:167]
    s_add_u32 s98, s98, 4096
    buffer_load_dwordx4 v[72:75], v2, s[48:51], s98 offen offset:0 sc1
    ds_read_b64_tr_b16 a[8:9], v9 offset:57344
    ds_read_b64_tr_b16 a[10:11], v9 offset:58368
    ds_read_b64_tr_b16 a[12:13], v9 offset:57600
    ds_read_b64_tr_b16 a[14:15], v9 offset:58624
    s_waitcnt vmcnt(7) lgkmcnt(8)
    v_mfma_f32_32x32x16_bf16 v[136:151], a[16:19], v[44:47], v[136:151]
    v_mfma_f32_32x32x16_bf16 v[152:167], a[20:23], v[44:47], v[152:167]
    buffer_load_dwordx4 v[76:79], v2, s[48:51], s98 offen offset:1024 sc1
    ds_read_b64_tr_b16 a[16:17], v170 offset:0
    ds_read_b64_tr_b16 a[18:19], v170 offset:1024
    ds_read_b64_tr_b16 a[20:21], v170 offset:256
    ds_read_b64_tr_b16 a[22:23], v170 offset:1280
    s_waitcnt vmcnt(7) lgkmcnt(8)
    v_mfma_f32_32x32x16_bf16 v[136:151], a[0:3], v[48:51], v[136:151]
    v_mfma_f32_32x32x16_bf16 v[152:167], a[4:7], v[48:51], v[152:167]
    buffer_load_dwordx4 v[80:83], v2, s[48:51], s98 offen offset:2048 sc1
    ds_read_b64_tr_b16 a[0:1], v170 offset:8192
    ds_read_b64_tr_b16 a[2:3], v170 offset:9216
    ds_read_b64_tr_b16 a[4:5], v170 offset:8448
    ds_read_b64_tr_b16 a[6:7], v170 offset:9472
    s_waitcnt vmcnt(7) lgkmcnt(8)
    v_mfma_f32_32x32x16_bf16 v[136:151], a[8:11], v[52:55], v[136:151]
    v_mfma_f32_32x32x16_bf16 v[152:167], a[12:15], v[52:55], v[152:167]
    buffer_load_dwordx4 v[84:87], v2, s[48:51], s98 offen offset:3072 sc1
    ds_read_b64_tr_b16 a[8:9], v170 offset:16384
    ds_read_b64_tr_b16 a[10:11], v170 offset:17408
    ds_read_b64_tr_b16 a[12:13], v170 offset:16640
    ds_read_b64_tr_b16 a[14:15], v170 offset:17664
    s_waitcnt vmcnt(7) lgkmcnt(8)
    v_mfma_f32_32x32x16_bf16 v[136:151], a[16:19], v[56:59], v[136:151]
    v_mfma_f32_32x32x16_bf16 v[152:167], a[20:23], v[56:59], v[152:167]
    s_add_u32 s98, s98, 4096
    buffer_load_dwordx4 v[88:91], v2, s[48:51], s98 offen offset:0 sc1
    ds_read_b64_tr_b16 a[16:17], v170 offset:24576
    ds_read_b64_tr_b16 a[18:19], v170 offset:25600
    ds_read_b64_tr_b16 a[20:21], v170 offset:24832
    ds_read_b64_tr_b16 a[22:23], v170 offset:25856
    s_waitcnt vmcnt(7) lgkmcnt(8)
    v_mfma_f32_32x32x16_bf16 v[136:151], a[0:3], v[60:63], v[136:151]
    v_mfma_f32_32x32x16_bf16 v[152:167], a[4:7], v[60:63], v[152:167]
    buffer_load_dwordx4 v[92:95], v2, s[48:51], s98 offen offset:1024 sc1
    s_waitcnt lgkmcnt(0)
    s_barrier
    ds_write_b128 v168, a[32:35] offset:0
    ds_write_b128 v168, a[36:39] offset:8192
    ds_write_b128 v168, a[40:43] offset:16384
    ds_write_b128 v168, a[44:47] offset:24576
    ds_write_b128 v168, a[48:51] offset:32768
    ds_write_b128 v168, a[52:55] offset:40960
    ds_write_b128 v168, a[56:59] offset:49152
    ds_write_b128 v168, a[60:63] offset:57344
    ds_write_b128 v169, v[184:187] offset:0
    ds_write_b128 v169, v[188:191] offset:8192
    ds_read_b64_tr_b16 a[0:1], v170 offset:32768
    ds_read_b64_tr_b16 a[2:3], v170 offset:33792
    ds_read_b64_tr_b16 a[4:5], v170 offset:33024
    ds_read_b64_tr_b16 a[6:7], v170 offset:34048
    s_waitcnt vmcnt(7)
    v_mfma_f32_32x32x16_bf16 v[136:151], a[8:11], v[64:67], v[136:151]
    v_mfma_f32_32x32x16_bf16 v[152:167], a[12:15], v[64:67], v[152:167]
    buffer_load_dwordx4 v[96:99], v2, s[48:51], s98 offen offset:2048 sc1
    ds_read_b64_tr_b16 a[8:9], v170 offset:40960
    ds_read_b64_tr_b16 a[10:11], v170 offset:41984
    ds_read_b64_tr_b16 a[12:13], v170 offset:41216
    ds_read_b64_tr_b16 a[14:15], v170 offset:42240
    s_waitcnt vmcnt(7)
    v_mfma_f32_32x32x16_bf16 v[136:151], a[16:19], v[68:71], v[136:151]
    v_mfma_f32_32x32x16_bf16 v[152:167], a[20:23], v[68:71], v[152:167]
    buffer_load_dwordx4 v[100:103], v2, s[48:51], s98 offen offset:3072 sc1
    ds_read_b64_tr_b16 a[16:17], v170 offset:49152
    ds_read_b64_tr_b16 a[18:19], v170 offset:50176
    ds_read_b64_tr_b16 a[20:21], v170 offset:49408
    ds_read_b64_tr_b16 a[22:23], v170 offset:50432
    s_waitcnt vmcnt(7) lgkmcnt(8)
    v_mfma_f32_32x32x16_bf16 v[136:151], a[0:3], v[72:75], v[136:151]
    v_mfma_f32_32x32x16_bf16 v[152:167], a[4:7], v[72:75], v[152:167]
    s_add_u32 s98, s98, 4096
    buffer_load_dwordx4 v[104:107], v2, s[48:51], s98 offen offset:0 sc1
    ds_read_b64_tr_b16 a[0:1], v170 offset:57344
    ds_read_b64_tr_b16 a[2:3], v170 offset:58368
    ds_read_b64_tr_b16 a[4:5], v170 offset:57600
    ds_read_b64_tr_b16 a[6:7], v170 offset:58624
    s_waitcnt vmcnt(7) lgkmcnt(8)
    v_mfma_f32_32x32x16_bf16 v[136:151], a[8:11], v[76:79], v[136:151]
    v_mfma_f32_32x32x16_bf16 v[152:167], a[12:15], v[76:79], v[152:167]
    buffer_load_dwordx4 v[108:111], v2, s[48:51], s98 offen offset:1024 sc1
    ds_read_b64_tr_b16 a[8:9], v171 offset:0
    ds_read_b64_tr_b16 a[10:11], v171 offset:1024
    ds_read_b64_tr_b16 a[12:13], v171 offset:256
    ds_read_b64_tr_b16 a[14:15], v171 offset:1280
    s_waitcnt vmcnt(7) lgkmcnt(8)
    s_waitcnt lgkmcnt(0)
    v_mfma_f32_32x32x16_bf16 v[136:151], a[16:19], v[80:83], v[136:151]
    v_mfma_f32_32x32x16_bf16 v[152:167], a[20:23], v[80:83], v[152:167]
    buffer_load_dwordx4 v[112:115], v2, s[48:51], s98 offen offset:2048 sc1
    ds_read_b64_tr_b16 a[16:17], v171 offset:8192
    ds_read_b64_tr_b16 a[18:19], v171 offset:9216
    ds_read_b64_tr_b16 a[20:21], v171 offset:8448
    ds_read_b64_tr_b16 a[22:23], v171 offset:9472
    s_waitcnt vmcnt(7)
    v_mfma_f32_32x32x16_bf16 v[136:151], a[0:3], v[84:87], v[136:151]
    v_mfma_f32_32x32x16_bf16 v[152:167], a[4:7], v[84:87], v[152:167]
    buffer_load_dwordx4 v[116:119], v2, s[48:51], s98 offen offset:3072 sc1
    s_waitcnt lgkmcnt(0)
    s_barrier
    ds_read_b64_tr_b16 a[0:1], v9 offset:0
    ds_read_b64_tr_b16 a[2:3], v9 offset:1024
    ds_read_b64_tr_b16 a[4:5], v9 offset:256
    ds_read_b64_tr_b16 a[6:7], v9 offset:1280
    s_waitcnt vmcnt(7)
    v_mfma_f32_32x32x16_bf16 v[136:151], a[8:11], v[88:91], v[136:151]
    v_mfma_f32_32x32x16_bf16 v[152:167], a[12:15], v[88:91], v[152:167]
    s_add_u32 s98, s98, 4096
    buffer_load_dwordx4 v[120:123], v2, s[48:51], s98 offen offset:0 sc1
    ds_read_b64_tr_b16 a[8:9], v9 offset:8192
    ds_read_b64_tr_b16 a[10:11], v9 offset:9216
    ds_read_b64_tr_b16 a[12:13], v9 offset:8448
    ds_read_b64_tr_b16 a[14:15], v9 offset:9472
    s_waitcnt vmcnt(7)
    v_mfma_f32_32x32x16_bf16 v[136:151], a[16:19], v[92:95], v[136:151]
    v_mfma_f32_32x32x16_bf16 v[152:167], a[20:23], v[92:95], v[152:167]
    buffer_load_dwordx4 v[124:127], v2, s[48:51], s98 offen offset:1024 sc1
    ds_read_b64_tr_b16 a[16:17], v9 offset:16384
    ds_read_b64_tr_b16 a[18:19], v9 offset:17408
    ds_read_b64_tr_b16 a[20:21], v9 offset:16640
    ds_read_b64_tr_b16 a[22:23], v9 offset:17664
    s_waitcnt vmcnt(7) lgkmcnt(8)
    v_mfma_f32_32x32x16_bf16 v[136:151], a[0:3], v[96:99], v[136:151]
    v_mfma_f32_32x32x16_bf16 v[152:167], a[4:7], v[96:99], v[152:167]
    buffer_load_dwordx4 v[128:131], v2, s[48:51], s98 offen offset:2048 sc1
    ds_read_b64_tr_b16 a[0:1], v9 offset:24576
    ds_read_b64_tr_b16 a[2:3], v9 offset:25600
    ds_read_b64_tr_b16 a[4:5], v9 offset:24832
    ds_read_b64_tr_b16 a[6:7], v9 offset:25856
    s_waitcnt vmcnt(7) lgkmcnt(8)
    v_mfma_f32_32x32x16_bf16 v[136:151], a[8:11], v[100:103], v[136:151]
    v_mfma_f32_32x32x16_bf16 v[152:167], a[12:15], v[100:103], v[152:167]
    buffer_load_dwordx4 v[132:135], v2, s[48:51], s98 offen offset:3072 sc1
    ds_read_b64_tr_b16 a[8:9], v9 offset:32768
    ds_read_b64_tr_b16 a[10:11], v9 offset:33792
    ds_read_b64_tr_b16 a[12:13], v9 offset:33024
    ds_read_b64_tr_b16 a[14:15], v9 offset:34048
    s_waitcnt vmcnt(7) lgkmcnt(8)
    v_mfma_f32_32x32x16_bf16 v[136:151], a[16:19], v[104:107], v[136:151]
    v_mfma_f32_32x32x16_bf16 v[152:167], a[20:23], v[104:107], v[152:167]
    ds_read_b64_tr_b16 a[16:17], v9 offset:40960
    ds_read_b64_tr_b16 a[18:19], v9 offset:41984
    ds_read_b64_tr_b16 a[20:21], v9 offset:41216
    ds_read_b64_tr_b16 a[22:23], v9 offset:42240
    s_waitcnt vmcnt(6) lgkmcnt(8)
    v_mfma_f32_32x32x16_bf16 v[136:151], a[0:3], v[108:111], v[136:151]
    v_mfma_f32_32x32x16_bf16 v[152:167], a[4:7], v[108:111], v[152:167]
    ds_read_b64_tr_b16 a[0:1], v9 offset:49152
    ds_read_b64_tr_b16 a[2:3], v9 offset:50176
    ds_read_b64_tr_b16 a[4:5], v9 offset:49408
    ds_read_b64_tr_b16 a[6:7], v9 offset:50432
    s_waitcnt vmcnt(5) lgkmcnt(8)
    v_mfma_f32_32x32x16_bf16 v[136:151], a[8:11], v[112:115], v[136:151]
    v_mfma_f32_32x32x16_bf16 v[152:167], a[12:15], v[112:115], v[152:167]
    ds_read_b64_tr_b16 a[8:9], v9 offset:57344
    ds_read_b64_tr_b16 a[10:11], v9 offset:58368
    ds_read_b64_tr_b16 a[12:13], v9 offset:57600
    ds_read_b64_tr_b16 a[14:15], v9 offset:58624
    s_waitcnt vmcnt(4) lgkmcnt(8)
    v_mfma_f32_32x32x16_bf16 v[136:151], a[16:19], v[116:119], v[136:151]
    v_mfma_f32_32x32x16_bf16 v[152:167], a[20:23], v[116:119], v[152:167]
    ds_read_b64_tr_b16 a[16:17], v170 offset:0
    ds_read_b64_tr_b16 a[18:19], v170 offset:1024
    ds_read_b64_tr_b16 a[20:21], v170 offset:256
    ds_read_b64_tr_b16 a[22:23], v170 offset:1280
    s_waitcnt vmcnt(3) lgkmcnt(8)
    v_mfma_f32_32x32x16_bf16 v[136:151], a[0:3], v[120:123], v[136:151]
    v_mfma_f32_32x32x16_bf16 v[152:167], a[4:7], v[120:123], v[152:167]
    ds_read_b64_tr_b16 a[0:1], v170 offset:8192
    ds_read_b64_tr_b16 a[2:3], v170 offset:9216
    ds_read_b64_tr_b16 a[4:5], v170 offset:8448
    ds_read_b64_tr_b16 a[6:7], v170 offset:9472
    s_waitcnt vmcnt(2) lgkmcnt(8)
    v_mfma_f32_32x32x16_bf16 v[136:151], a[8:11], v[124:127], v[136:151]
    v_mfma_f32_32x32x16_bf16 v[152:167], a[12:15], v[124:127], v[152:167]
    s_waitcnt vmcnt(1) lgkmcnt(4)
    v_mfma_f32_32x32x16_bf16 v[136:151], a[16:19], v[128:131], v[136:151]
    v_mfma_f32_32x32x16_bf16 v[152:167], a[20:23], v[128:131], v[152:167]
    s_waitcnt vmcnt(0) lgkmcnt(0)
    v_mfma_f32_32x32x16_bf16 v[136:151], a[0:3], v[132:135], v[136:151]
    v_mfma_f32_32x32x16_bf16 v[152:167], a[4:7], v[132:135], v[152:167]
    ds_read_b128 v[56:59], v12 offset:10240
    ds_read_b128 v[60:63], v12 offset:10272
    s_waitcnt lgkmcnt(0)
    s_barrier
    s_nop 6
    ds_write_b128 v10, v[136:139] offset:0
    ds_write_b128 v10, v[140:143] offset:1024
    ds_write_b128 v10, v[144:147] offset:2048
    ds_write_b128 v10, v[148:151] offset:3072
    ds_write_b128 v10, v[152:155] offset:4096
    ds_write_b128 v10, v[156:159] offset:5120
    ds_write_b128 v10, v[160:163] offset:6144
    ds_write_b128 v10, v[164:167] offset:7168
    s_waitcnt lgkmcnt(0)
    s_barrier
    ds_read_b128 v[24:27], v11 offset:0
    ds_read_b128 v[28:31], v11 offset:1024
    ds_read_b128 v[32:35], v11 offset:16384
    ds_read_b128 v[36:39], v11 offset:17408
    ds_read_b128 v[40:43], v11 offset:32768
    ds_read_b128 v[44:47], v11 offset:33792
    ds_read_b128 v[48:51], v11 offset:49152
    ds_read_b128 v[52:55], v11 offset:50176
    v_lshlrev_b32 v64, 16, v16
    v_and_b32 v65, 0xffff0000, v16
    v_lshlrev_b32 v66, 16, v17
    v_and_b32 v67, 0xffff0000, v17
    v_lshlrev_b32 v68, 16, v18
    v_and_b32 v69, 0xffff0000, v18
    v_lshlrev_b32 v70, 16, v19
    v_and_b32 v71, 0xffff0000, v19
    v_lshlrev_b32 v72, 16, v20
    v_and_b32 v73, 0xffff0000, v20
    v_lshlrev_b32 v74, 16, v21
    v_and_b32 v75, 0xffff0000, v21
    v_lshlrev_b32 v76, 16, v22
    v_and_b32 v77, 0xffff0000, v22
    v_lshlrev_b32 v78, 16, v23
    v_and_b32 v79, 0xffff0000, v23
    s_waitcnt lgkmcnt(0)
    v_add_f32 v24, v24, v32
    v_add_f32 v25, v25, v33
    v_add_f32 v26, v26, v34
    v_add_f32 v27, v27, v35
    v_add_f32 v28, v28, v36
    v_add_f32 v29, v29, v37
    v_add_f32 v30, v30, v38
    v_add_f32 v31, v31, v39
    v_add_f32 v40, v40, v48
    v_add_f32 v41, v41, v49
    v_add_f32 v42, v42, v50
    v_add_f32 v43, v43, v51
    v_add_f32 v44, v44, v52
    v_add_f32 v45, v45, v53
    v_add_f32 v46, v46, v54
    v_add_f32 v47, v47, v55
    v_add_f32 v24, v24, v40
    v_add_f32 v25, v25, v41
    v_add_f32 v26, v26, v42
    v_add_f32 v27, v27, v43
    v_add_f32 v28, v28, v44
    v_add_f32 v29, v29, v45
    v_add_f32 v30, v30, v46
    v_add_f32 v31, v31, v47
    v_add_f32 v24, v24, v72
    v_add_f32 v25, v25, v73
    v_add_f32 v26, v26, v74
    v_add_f32 v27, v27, v75
    v_add_f32 v28, v28, v76
    v_add_f32 v29, v29, v77
    v_add_f32 v30, v30, v78
    v_add_f32 v31, v31, v79
    v_fma_f32 v64, v24, v56, v64
    v_fma_f32 v65, v25, v57, v65
    v_fma_f32 v66, v26, v58, v66
    v_fma_f32 v67, v27, v59, v67
    v_fma_f32 v68, v28, v60, v68
    v_fma_f32 v69, v29, v61, v69
    v_fma_f32 v70, v30, v62, v70
    v_fma_f32 v71, v31, v63, v71
    v_cvt_pk_bf16_f32 v80, v64, v65
    v_cvt_pk_bf16_f32 v81, v66, v67
    v_cvt_pk_bf16_f32 v82, v68, v69
    v_cvt_pk_bf16_f32 v83, v70, v71
    s_mov_b32 vcc_lo, 0xff00ff
    s_mov_b32 vcc_hi, 0xff00ff
    v_cndmask_b32_dpp v84, v82, v80, vcc row_ror:8 row_mask:0xf bank_mask:0xf
    v_cndmask_b32_dpp v85, v83, v81, vcc row_ror:8 row_mask:0xf bank_mask:0xf
    s_mov_b32 vcc_lo, 0xff00ff00
    s_mov_b32 vcc_hi, 0xff00ff00
    v_cndmask_b32_dpp v86, v80, v82, vcc row_ror:8 row_mask:0xf bank_mask:0xf
    v_cndmask_b32_dpp v87, v81, v83, vcc row_ror:8 row_mask:0xf bank_mask:0xf
    buffer_store_dwordx4 v[84:87], v13, s[40:43], s66 offen
    s_cmp_lg_u32 s52, 7
    s_cbranch_scc1 FIN
    v_readfirstlane_b32 s62, v6
    s_nop 0
    s_cmp_lg_u32 s62, 255
    s_cbranch_scc1 FIN
    v_mov_b32 v14, 0
    v_mov_b32 v15, s55
    s_mov_b64 exec, 1
    buffer_store_dword v15, v14, s[48:51], 0 offen sc1
    s_mov_b64 exec, -1
FIN:
    s_waitcnt vmcnt(0)
END:
    s_endpgm
.section .rodata,"a"
.p2align 6
.amdhsa_kernel adaLN_cond__sliding_block__dense_activation_squared_relu__prompt_kernel
  .amdhsa_next_free_vgpr 256
  .amdhsa_next_free_sgpr 102
  .amdhsa_accum_offset 192
  .amdhsa_group_segment_fixed_size 0
  .amdhsa_kernarg_size 104
  .amdhsa_user_sgpr_count 2
  .amdhsa_user_sgpr_kernarg_segment_ptr 1
  .amdhsa_system_sgpr_workgroup_id_x 1
.end_amdhsa_kernel
```
